```python
import torch

def _softmax(x, axis=-1):
    return torch.softmax(x, dim=axis)
def _gelu(x):
    return torch.nn.functional.gelu(x, approximate="tanh")
def _silu(x):
    return torch.nn.functional.silu(x)
def _sigmoid(x):
    return torch.sigmoid(x)
def _layernorm(x, axis=-1, eps=1e-5):
    m = x.mean(dim=axis, keepdim=True)
    v = x.var(dim=axis, keepdim=True, unbiased=False)
    return (x - m) / torch.sqrt(v + eps)
def _scatter_add(tgt, idx, src, axis=0):
    return tgt.clone().index_add_(axis, idx, src)
def _segment_sum(src, seg, n):
    out = torch.zeros((n,) + src.shape[1:], dtype=src.dtype)
    return out.index_add_(0, seg, src)
def _pad(x, pw):
    flat = tuple(v for pair in reversed(pw) for v in pair)
    return torch.nn.functional.pad(x, flat)

kernel_name = 'concat_heads__sliding_block_cached__sliding_block_cached__decode'

def setup_inputs():

    _w = (lambda a: (lambda t: t.to(torch.bfloat16) if t.is_floating_point() else t)(torch.as_tensor(a)))
    def _A_setup():
        B, Sq, D = 1, 1, 640
        Hq, Hkv, Sk, Dh = 32, 32, 4096, 192
        assert Hq % Hkv == 0, (Hq, Hkv)
        return {
            "x": _w((lambda *s: torch.randn(*s, dtype=torch.bfloat16) * 1.6)(B, Sq, D)),
            "k_cache": _w((lambda *s: torch.randn(*s, dtype=torch.bfloat16) * 1.6)(B, Hkv, Sk, Dh)),
            "v_cache": _w((lambda *s: torch.randn(*s, dtype=torch.bfloat16) * 0.05)(B, Hkv, Sk, Dh)),
            "wq": _w((lambda *s: torch.randn(*s, dtype=torch.bfloat16) * 1.6)(D, Hq * Dh) * (D ** -0.5)),
            "wo": _w((lambda *s: torch.randn(*s, dtype=torch.bfloat16) * 0.05)(Hq * Dh, D) * ((Hq * Dh) ** -0.5)),
        }
    _A_in = _A_setup()

    def _B_setup():
        B, Sq, D = 1, 1, 640
        Hq, Hkv, Sk, Dh = 32, 32, 4096, 192
        assert Hq % Hkv == 0, (Hq, Hkv)
        return {
            "x": _w((lambda *s: torch.randn(*s, dtype=torch.bfloat16) * 1.6)(B, Sq, D)),
            "k_cache": _w((lambda *s: torch.randn(*s, dtype=torch.bfloat16) * 1.6)(B, Hkv, Sk, Dh)),
            "v_cache": _w((lambda *s: torch.randn(*s, dtype=torch.bfloat16) * 0.05)(B, Hkv, Sk, Dh)),
            "wq": _w((lambda *s: torch.randn(*s, dtype=torch.bfloat16) * 1.6)(D, Hq * Dh) * (D ** -0.5)),
            "wo": _w((lambda *s: torch.randn(*s, dtype=torch.bfloat16) * 0.05)(Hq * Dh, D) * ((Hq * Dh) ** -0.5)),
        }
    _B_in = _B_setup()

    return {
        "A_x": _A_in["x"],
        "A_k_cache": _A_in["k_cache"],
        "A_v_cache": _A_in["v_cache"],
        "A_wq": _A_in["wq"],
        "A_wo": _A_in["wo"],
        "B_x": _B_in["x"],
        "B_k_cache": _B_in["k_cache"],
        "B_v_cache": _B_in["v_cache"],
        "B_wq": _B_in["wq"],
        "B_wo": _B_in["wo"],
    }

def reference(A_x, A_k_cache, A_v_cache, A_wq, A_wo, B_x, B_k_cache, B_v_cache, B_wq, B_wo):
    def _A_ref(x, k_cache, v_cache, wq, wo):
        B, Sq, D = x.shape
        Hq, Dh = 32, 192
        Hkv, Sk = k_cache.shape[1], k_cache.shape[2]
        W = min(4096, max(256, Sk // 4))
        rep = Hq // Hkv
        q = (lambda x, *d: x.permute(*d))((x @ wq).reshape(B, Sq, Hq, Dh), 0, 2, 1, 3)
        k = (lambda x, n, axis: torch.repeat_interleave(x, n, dim=axis))(k_cache[:, :, Sk - W:, :], rep, axis=1)
        v = (lambda x, n, axis: torch.repeat_interleave(x, n, dim=axis))(v_cache[:, :, Sk - W:, :], rep, axis=1)
        scores = torch.einsum("bhqd,bhkd->bhqk", q, k) * (Dh ** -0.5)
        p = _softmax(scores, axis=-1)
        o = torch.einsum("bhqk,bhkd->bhqd", p, v)
        return (lambda x, *d: x.permute(*d))(o, 0, 2, 1, 3).reshape(B, Sq, Hq * Dh) @ wo

    def _B_ref(x, k_cache, v_cache, wq, wo):
        B, Sq, D = x.shape
        Hq, Dh = 32, 192
        Hkv, Sk = k_cache.shape[1], k_cache.shape[2]
        W = min(4096, max(256, Sk // 4))
        rep = Hq // Hkv
        q = (lambda x, *d: x.permute(*d))((x @ wq).reshape(B, Sq, Hq, Dh), 0, 2, 1, 3)
        k = (lambda x, n, axis: torch.repeat_interleave(x, n, dim=axis))(k_cache[:, :, Sk - W:, :], rep, axis=1)
        v = (lambda x, n, axis: torch.repeat_interleave(x, n, dim=axis))(v_cache[:, :, Sk - W:, :], rep, axis=1)
        scores = torch.einsum("bhqd,bhkd->bhqk", q, k) * (Dh ** -0.5)
        p = _softmax(scores, axis=-1)
        o = torch.einsum("bhqk,bhkd->bhqd", p, v)
        return (lambda x, *d: x.permute(*d))(o, 0, 2, 1, 3).reshape(B, Sq, Hq * Dh) @ wo

    a = _A_ref(A_x, A_k_cache, A_v_cache, A_wq, A_wo)
    b = _B_ref(B_x, B_k_cache, B_v_cache, B_wq, B_wo)
    return torch.concatenate([a, b], axis=-1)
```

```asm
; @launch grid=(256,1,1) block=(1024,1,1) lds=10752
.amdgcn_target "amdgcn-amd-amdhsa--gfx950"
.text
.globl concat_heads__sliding_block_cached__sliding_block_cached__decode_kernel
.p2align 8
.type concat_heads__sliding_block_cached__sliding_block_cached__decode_kernel,@function
concat_heads__sliding_block_cached__sliding_block_cached__decode_kernel:
  s_load_dwordx16 s[4:19], s[0:1], 0
  s_load_dwordx8 s[20:27], s[0:1], 64
  s_load_dwordx2 s[28:29], s[0:1], 96
  s_cmp_ge_u32 s2, 256
  s_cbranch_scc1 L_end0
  s_getpc_b64 s[32:33]
L_pc:
  v_lshlrev_b32 v5, 7, v0
  v_subrev_u32 v5, 0x12000, v5
  v_cmp_gt_u32 vcc, L_end0-L_pc, v5
  s_bfe_u32 s34, s2, 0x20003
  s_cmp_lg_u32 s34, 3
  s_cbranch_scc1 L_nopf
  s_and_b64 exec, exec, vcc
  s_cbranch_execz L_nopf1
  global_load_dword v6, v5, s[32:33]
L_nopf1:
  s_mov_b64 exec, -1
L_nopf:
  v_lshrrev_b32 v1, 6, v0
  v_and_b32 v2, 63, v0
  v_readfirstlane_b32 s3, v1
  s_and_b32 s96, s2, 7
  s_lshr_b32 s99, s2, 5
  s_lshl_b32 s99, s99, 3
  s_or_b32 s96, s96, s99
  s_lshr_b32 s99, s2, 3
  s_and_b32 s99, s99, 3
  s_lshr_b32 s97, s96, 5
  s_and_b32 s98, s96, 31
  s_mov_b32 s100, 0x200000
  v_mov_b32 v10, 0
  v_mov_b32 v11, 1
  v_lshlrev_b32 v12, 2, v2
  ds_write_b32 v12, v10
  v_lshrrev_b32 v3, 3, v2
  v_and_b32 v4, 7, v2
  v_lshlrev_b32 v1, 6, v2
  s_lshl_b32 s31, s97, 8
  s_lshl_b32 s0, s96, 15
  s_add_u32 s1, s31, 0x900000
  s_cmp_ge_u32 s3, 4
  s_cbranch_scc1 L_nw
  s_mul_i32 s33, s99, 1792
  s_add_u32 s33, s33, s0
  s_add_u32 s33, s33, 7168
  v_lshl_add_u32 v126, v2, 7, s33
  s_mov_b32 s38, 7864320
  s_mov_b32 s39, 0x20000
  v_mul_u32_u24 v5, 12288, v3
  v_lshl_add_u32 v5, v4, 4, v5
  s_lshl_b32 s35, s99, 2
  s_add_u32 s35, s35, s3
  s_mul_i32 s34, s35, 491520
  s_mul_i32 s32, s98, 384
  s_add_u32 s34, s34, s32
  s_cmp_eq_u32 s3, 0
  s_cselect_b32 exec_lo, 0x3fff, 0
  s_mov_b32 exec_hi, 0
  s_cmp_lg_u32 s97, 0
  s_waitcnt lgkmcnt(0)
  global_load_dword v127, v126, s[28:29] nt
  s_mov_b64 exec, -1
  s_cselect_b64 s[36:37], s[20:21], s[10:11]
  s_and_b32 s37, s37, 0xffff
  buffer_load_dwordx4 v[16:19], v5, s[36:39], s34 offen offset:0 nt
  buffer_load_dwordx4 v[20:23], v5, s[36:39], s34 offen offset:128 nt
  buffer_load_dwordx4 v[24:27], v5, s[36:39], s34 offen offset:256 nt
  s_add_u32 s34, s34, 98304
  buffer_load_dwordx4 v[28:31], v5, s[36:39], s34 offen offset:0 nt
  buffer_load_dwordx4 v[32:35], v5, s[36:39], s34 offen offset:128 nt
  buffer_load_dwordx4 v[36:39], v5, s[36:39], s34 offen offset:256 nt
  s_add_u32 s34, s34, 98304
  buffer_load_dwordx4 v[40:43], v5, s[36:39], s34 offen offset:0 nt
  buffer_load_dwordx4 v[44:47], v5, s[36:39], s34 offen offset:128 nt
  buffer_load_dwordx4 v[48:51], v5, s[36:39], s34 offen offset:256 nt
  s_add_u32 s34, s34, 98304
  buffer_load_dwordx4 v[52:55], v5, s[36:39], s34 offen offset:0 nt
  buffer_load_dwordx4 v[56:59], v5, s[36:39], s34 offen offset:128 nt
  buffer_load_dwordx4 v[60:63], v5, s[36:39], s34 offen offset:256 nt
  s_add_u32 s34, s34, 98304
  buffer_load_dwordx4 v[64:67], v5, s[36:39], s34 offen offset:0 nt
  buffer_load_dwordx4 v[68:71], v5, s[36:39], s34 offen offset:128 nt
  buffer_load_dwordx4 v[72:75], v5, s[36:39], s34 offen offset:256 nt
  s_cmp_lg_u32 s97, 0
  s_load_dword s30, s[28:29], s31
  s_load_dword s2, s[28:29], s1
  s_cselect_b64 s[4:5], s[14:15], s[4:5]
  s_cselect_b64 s[12:13], s[22:23], s[12:13]
  s_add_u32 s31, s0, 0x1000
  s_mov_b32 s20, s28
  s_and_b32 s21, s29, 0xffff
  s_mov_b32 s22, 268435456
  s_mov_b32 s23, 0x20000
  s_barrier
  s_mul_i32 s15, s35, 80
  s_load_dwordx16 s[32:47], s[4:5], s15
  s_load_dwordx4 s[48:51], s[4:5], s15 offset:64
  v_and_b32 v92, 1, v4
  v_cmp_eq_u32 vcc, 1, v92
  v_mov_b32 v93, 0x0c0c0100
  v_mov_b32 v94, 0x01000c0c
  v_mov_b32 v95, 0x0c0c0c0c
  v_cndmask_b32 v93, v93, v94, vcc
  v_mov_b32 v94, 0x0c0c0302
  v_mov_b32 v92, 0x03020c0c
  v_cndmask_b32 v94, v94, v92, vcc
  v_lshrrev_b32 v92, 1, v4
  v_cmp_eq_u32 vcc, 0, v92
  s_nop 1
  v_cndmask_b32 v84, v95, v93, vcc
  v_cndmask_b32 v85, v95, v94, vcc
  v_cmp_eq_u32 vcc, 1, v92
  s_nop 1
  v_cndmask_b32 v86, v95, v93, vcc
  v_cndmask_b32 v87, v95, v94, vcc
  v_cmp_eq_u32 vcc, 2, v92
  s_nop 1
  v_cndmask_b32 v88, v95, v93, vcc
  v_cndmask_b32 v89, v95, v94, vcc
  v_cmp_eq_u32 vcc, 3, v92
  s_nop 1
  v_cndmask_b32 v90, v95, v93, vcc
  v_cndmask_b32 v91, v95, v94, vcc
  v_and_b32 v92, 1, v3
  v_cmp_eq_u32 vcc, 1, v92
  v_lshrrev_b32 v7, 5, v2
  v_mul_u32_u24 v7, 768, v7
  v_cndmask_b32 v84, v84, v85, vcc
  v_cndmask_b32 v86, v86, v87, vcc
  v_cndmask_b32 v88, v88, v89, vcc
  v_cndmask_b32 v90, v90, v91, vcc
  v_lshl_add_u32 v7, v4, 5, v7
  v_bfe_u32 v14, v2, 4, 1
  v_lshl_add_u32 v7, v14, 4, v7
  s_mul_i32 s14, s3, 1536
  v_add_u32 v7, s14, v7
  v_lshlrev_b32 v14, 4, v2
  s_mul_i32 s4, s99, 0x300
  s_add_u32 s4, s4, s31
  s_lshl_b32 s5, s99, 2
  s_add_u32 s5, s5, s31
  s_add_u32 s5, s5, 0xc00
  s_mov_b32 s7, 0x07060501
  s_mov_b32 s8, 0x07060502
  s_mov_b32 s9, 0x07060503
  s_mul_i32 s14, s99, 0x300-16
  s_sub_u32 s14, 0, s14
  v_add_u32 v8, s14, v1
  v_cmp_gt_u32 vcc, 48, v2
  s_nop 1
  v_cndmask_b32 v8, v8, v14, vcc
  s_waitcnt lgkmcnt(0)
  s_add_u32 s30, s30, 0x9e3779b9
  s_add_u32 s30, s30, s2
  s_mov_b32 exec_lo, 0xffff
  s_mov_b32 exec_hi, 0
  v_mov_b32 v76, s32
  v_mov_b32 v77, s36
  v_mov_b32 v78, s40
  v_mov_b32 v79, s44
  v_mov_b32 v80, s48
  s_mov_b32 exec_lo, 0xffff0000
  s_mov_b32 exec_hi, 0
  v_mov_b32 v76, s33
  v_mov_b32 v77, s37
  v_mov_b32 v78, s41
  v_mov_b32 v79, s45
  v_mov_b32 v80, s49
  s_mov_b32 exec_lo, 0
  s_mov_b32 exec_hi, 0xffff
  v_mov_b32 v76, s34
  v_mov_b32 v77, s38
  v_mov_b32 v78, s42
  v_mov_b32 v79, s46
  v_mov_b32 v80, s50
  s_mov_b32 exec_lo, 0
  s_mov_b32 exec_hi, 0xffff0000
  v_mov_b32 v76, s35
  v_mov_b32 v77, s39
  v_mov_b32 v78, s43
  v_mov_b32 v79, s47
  v_mov_b32 v80, s51
  s_mov_b64 exec, -1
  v_perm_b32 v92, v76, v76, v84
  v_perm_b32 v93, v76, v76, v86
  v_perm_b32 v94, v76, v76, v88
  v_perm_b32 v95, v76, v76, v90
  s_waitcnt vmcnt(12)
  s_nop 0
  v_mfma_f32_16x16x32_bf16 v[100:103], v[92:95], v[16:19], 0
  v_mfma_f32_16x16x32_bf16 v[104:107], v[92:95], v[20:23], 0
  v_mfma_f32_16x16x32_bf16 v[108:111], v[92:95], v[24:27], 0
  v_perm_b32 v96, v77, v77, v84
  v_perm_b32 v97, v77, v77, v86
  v_perm_b32 v98, v77, v77, v88
  v_perm_b32 v99, v77, v77, v90
  s_waitcnt vmcnt(9)
  s_nop 0
  v_mfma_f32_16x16x32_bf16 v[100:103], v[96:99], v[28:31], v[100:103]
  v_mfma_f32_16x16x32_bf16 v[104:107], v[96:99], v[32:35], v[104:107]
  v_mfma_f32_16x16x32_bf16 v[108:111], v[96:99], v[36:39], v[108:111]
  v_perm_b32 v92, v78, v78, v84
  v_perm_b32 v93, v78, v78, v86
  v_perm_b32 v94, v78, v78, v88
  v_perm_b32 v95, v78, v78, v90
  s_waitcnt vmcnt(6)
  s_nop 0
  v_mfma_f32_16x16x32_bf16 v[100:103], v[92:95], v[40:43], v[100:103]
  v_mfma_f32_16x16x32_bf16 v[104:107], v[92:95], v[44:47], v[104:107]
  v_mfma_f32_16x16x32_bf16 v[108:111], v[92:95], v[48:51], v[108:111]
  v_perm_b32 v96, v79, v79, v84
  v_perm_b32 v97, v79, v79, v86
  v_perm_b32 v98, v79, v79, v88
  v_perm_b32 v99, v79, v79, v90
  s_waitcnt vmcnt(3)
  s_mov_b64 exec, 1
  ds_add_u32 v10, v11 offset:40
  s_mov_b64 exec, -1
  v_mfma_f32_16x16x32_bf16 v[100:103], v[96:99], v[52:55], v[100:103]
  v_mfma_f32_16x16x32_bf16 v[104:107], v[96:99], v[56:59], v[104:107]
  v_mfma_f32_16x16x32_bf16 v[108:111], v[96:99], v[60:63], v[108:111]
  v_perm_b32 v92, v80, v80, v84
  v_perm_b32 v93, v80, v80, v86
  v_perm_b32 v94, v80, v80, v88
  v_perm_b32 v95, v80, v80, v90
  s_waitcnt vmcnt(0)
  s_nop 0
  v_mfma_f32_16x16x32_bf16 v[100:103], v[92:95], v[64:67], v[100:103]
  v_mfma_f32_16x16x32_bf16 v[104:107], v[92:95], v[68:71], v[104:107]
  v_mfma_f32_16x16x32_bf16 v[108:111], v[92:95], v[72:75], v[108:111]
  s_setprio 3
  v_mov_b32 v23, s30
  s_getreg_b32 s14, hwreg(HW_REG_XCC_ID, 0, 4)
  s_add_u32 s14, s14, s30
  s_add_u32 s14, s14, 1
  v_mov_b32 v19, s14
  v_mov_b32 v20, s14
  s_mov_b32 exec_lo, 0x00ff00ff
  s_mov_b32 exec_hi, 0xff00ff00
  s_nop 4
  ds_write_b128 v7, v[100:103] offset:4096
  ds_write_b128 v7, v[104:107] offset:4352
  ds_write_b128 v7, v[108:111] offset:4608
  s_mov_b64 exec, 1
  ds_add_rtn_u32 v13, v10, v11 offset:0
  s_mov_b64 exec, -1
  s_waitcnt lgkmcnt(0)
  v_readfirstlane_b32 s101, v13
  s_cmp_lg_u32 s101, 3
  s_cbranch_scc1 L_tk
  s_mov_b32 exec_lo, -1
  s_mov_b32 exec_hi, 0xffff
  ds_read_b128 v[24:27], v14 offset:4096
  ds_read_b128 v[28:31], v14 offset:4864
  ds_read_b128 v[32:35], v14 offset:5632
  ds_read_b128 v[36:39], v14 offset:6400
  ds_read_b128 v[40:43], v14 offset:7168
  ds_read_b128 v[44:47], v14 offset:7936
  ds_read_b128 v[48:51], v14 offset:8704
  ds_read_b128 v[52:55], v14 offset:9472
  s_waitcnt lgkmcnt(6)
  v_pk_add_f32 v[24:25], v[24:25], v[28:29]
  v_pk_add_f32 v[26:27], v[26:27], v[30:31]
  s_waitcnt lgkmcnt(4)
  v_pk_add_f32 v[32:33], v[32:33], v[36:37]
  v_pk_add_f32 v[34:35], v[34:35], v[38:39]
  s_waitcnt lgkmcnt(2)
  v_pk_add_f32 v[40:41], v[40:41], v[44:45]
  v_pk_add_f32 v[42:43], v[42:43], v[46:47]
  s_waitcnt lgkmcnt(0)
  v_pk_add_f32 v[48:49], v[48:49], v[52:53]
  v_pk_add_f32 v[50:51], v[50:51], v[54:55]
  v_pk_add_f32 v[24:25], v[24:25], v[32:33]
  v_pk_add_f32 v[26:27], v[26:27], v[34:35]
  v_pk_add_f32 v[40:41], v[40:41], v[48:49]
  v_pk_add_f32 v[42:43], v[42:43], v[50:51]
  v_pk_add_f32 v[24:25], v[24:25], v[40:41]
  v_pk_add_f32 v[26:27], v[26:27], v[42:43]
  v_perm_b32 v20, v24, v27, s7
  v_perm_b32 v21, v25, v27, s8
  v_perm_b32 v22, v26, v27, s9
  s_mov_b64 exec, -1
  buffer_store_dwordx4 v[20:23], v8, s[20:23], s4 offen
  s_mov_b32 exec_lo, -1
  s_mov_b32 exec_hi, 0xffff
  s_add_u32 s4, s4, 0x3000
  buffer_store_dwordx4 v[20:23], v14, s[20:23], s4 offen
  s_add_u32 s4, s4, 0x2000
  buffer_store_dwordx4 v[20:23], v14, s[20:23], s4 offen
  ds_write_b128 v14, v[20:23] offset:3328
  s_mov_b64 exec, 1
  ds_add_u32 v10, v11 offset:12
  s_mov_b64 exec, -1
L_tk:
  s_sub_u32 s14, s3, 7
  s_max_i32 s14, s14, 0
  s_cmp_lt_u32 s3, 3
  s_cselect_b32 s14, s3, s14
  s_cselect_b32 s11, 0, 0x200
  s_mul_i32 s32, s14, 768
  s_add_u32 s32, s32, s11
  v_lshlrev_b32 v117, 4, v2
  v_add_u32 v116, s32, v117
  s_add_u32 s14, s14, 1
  s_xor_b32 s14, s14, s99
  s_lshl_b32 s15, s14, 4
  s_add_u32 s15, s15, s31
  s_add_u32 s15, s15, 0xc00
  s_mul_i32 s8, s14, 0x300
  s_add_u32 s8, s8, s11
  s_add_u32 s8, s8, s31
  s_lshl_b32 s9, s14, 10
  s_add_u32 s9, s9, s11
  s_lshl_b32 s34, s96, 12
  s_add_u32 s34, s34, 0x201000
  s_add_u32 s9, s9, s34
  s_getreg_b32 s33, hwreg(HW_REG_XCC_ID, 0, 4)
  s_add_u32 s33, s33, s30
  s_add_u32 s33, s33, 1
L_spin1:
  ds_read_b32 v13, v10 offset:12
  s_waitcnt lgkmcnt(0)
  v_readfirstlane_b32 s101, v13
  s_cmp_ge_u32 s101, 1
  s_cbranch_scc1 L_spin1_done
  s_sub_u32 s100, s100, 1
  s_cbranch_scc1 L_end
  s_branch L_spin1
L_spin1_done:
  s_load_dword s32, s[28:29], s15 offset:0
  s_waitcnt lgkmcnt(0)
  s_cmp_eq_u32 s32, s33
  s_cbranch_scc1 L_qb_seen
  s_sleep 1
  s_load_dword s32, s[28:29], s15 offset:64
  s_waitcnt lgkmcnt(0)
  s_cmp_eq_u32 s32, s33
  s_cbranch_scc1 L_qb_seen
  s_sleep 1
  s_load_dword s32, s[28:29], s15 offset:128
  s_waitcnt lgkmcnt(0)
  s_cmp_eq_u32 s32, s33
  s_cbranch_scc1 L_qb_seen
  s_sleep 1
  s_load_dword s32, s[28:29], s15 offset:192
  s_waitcnt lgkmcnt(0)
  s_cmp_eq_u32 s32, s33
  s_cbranch_scc1 L_qb_seen
  s_sleep 1
  s_load_dword s32, s[28:29], s15 offset:256
  s_waitcnt lgkmcnt(0)
  s_cmp_eq_u32 s32, s33
  s_cbranch_scc1 L_qb_seen
  s_sleep 1
  s_load_dword s32, s[28:29], s15 offset:320
  s_waitcnt lgkmcnt(0)
  s_cmp_eq_u32 s32, s33
  s_cbranch_scc1 L_qb_seen
  s_sleep 1
  s_load_dword s32, s[28:29], s15 offset:384
  s_waitcnt lgkmcnt(0)
  s_cmp_eq_u32 s32, s33
  s_cbranch_scc1 L_qb_seen
  s_sleep 3
  s_load_dword s32, s[28:29], s15 offset:448
  s_waitcnt lgkmcnt(0)
  s_cmp_eq_u32 s32, s33
  s_cbranch_scc1 L_qb_seen
  s_sleep 3
  s_load_dword s32, s[28:29], s15 offset:512
  s_waitcnt lgkmcnt(0)
  s_cmp_eq_u32 s32, s33
  s_cbranch_scc1 L_qb_seen
  s_sleep 3
  s_load_dword s32, s[28:29], s15 offset:576
  s_waitcnt lgkmcnt(0)
  s_cmp_eq_u32 s32, s33
  s_cbranch_scc1 L_qb_seen
  s_sleep 3
  s_load_dword s32, s[28:29], s15 offset:640
  s_waitcnt lgkmcnt(0)
  s_cmp_eq_u32 s32, s33
  s_cbranch_scc1 L_qb_seen
  s_sleep 6
  s_load_dword s32, s[28:29], s15 offset:704
  s_waitcnt lgkmcnt(0)
  s_cmp_eq_u32 s32, s33
  s_cbranch_scc1 L_qb_seen
  s_sleep 6
  s_load_dword s32, s[28:29], s15 offset:768
  s_waitcnt lgkmcnt(0)
  s_cmp_eq_u32 s32, s33
  s_cbranch_scc1 L_qb_seen
  s_sleep 6
  s_load_dword s32, s[28:29], s15 offset:832
  s_waitcnt lgkmcnt(0)
  s_cmp_eq_u32 s32, s33
  s_cbranch_scc1 L_qb_seen
  s_sleep 12
  s_load_dword s32, s[28:29], s15 offset:896
  s_waitcnt lgkmcnt(0)
  s_cmp_eq_u32 s32, s33
  s_cbranch_scc1 L_qb_seen
  s_sleep 12
  s_load_dword s32, s[28:29], s15 offset:960
  s_waitcnt lgkmcnt(0)
  s_cmp_eq_u32 s32, s33
  s_cbranch_scc1 L_qb_seen
  s_mov_b32 exec_lo, -1
  s_mov_b32 exec_hi, 0xffff
  ds_read_b128 v[112:115], v117 offset:3328
  ds_write_b32 v10, v11 offset:64
  s_lshl_b32 s14, s99, 10
  s_add_u32 s14, s14, s34
  s_waitcnt lgkmcnt(0)
  buffer_store_dwordx4 v[112:115], v117, s[20:23], s14 offen sc1
  s_mov_b64 exec, -1
  s_mov_b32 s15, 0
L_qb_slow:
  s_sub_u32 s100, s100, 64
  s_cbranch_scc1 L_end
  s_mov_b32 exec_lo, 0xffff
  s_mov_b32 exec_hi, 0
  buffer_load_dwordx4 v[112:115], v117, s[20:23], s8 offen sc1
  buffer_load_dwordx4 v[124:127], v117, s[20:23], s9 offen sc1
  s_waitcnt vmcnt(0)
  v_cmp_eq_u32 vcc, s30, v127
  v_cndmask_b32 v112, v112, v124, vcc
  v_cndmask_b32 v113, v113, v125, vcc
  v_cndmask_b32 v114, v114, v126, vcc
  v_cndmask_b32 v115, v115, v127, vcc
  v_cmp_ne_u32 vcc, s30, v115
  s_mov_b64 exec, -1
  s_cmp_lg_u64 vcc, 0
  s_cbranch_scc1 L_qb_slow
  s_branch L_qb_put
L_qb_seen:
L_qb_fast:
  s_mov_b32 s14, s8
  s_load_dwordx16 s[32:47], s[28:29], s14 offset:0
  s_load_dwordx16 s[48:63], s[28:29], s14 offset:64
  s_load_dwordx16 s[64:79], s[28:29], s14 offset:128
  s_load_dwordx16 s[80:95], s[28:29], s14 offset:192
  v_mov_b32 v115, s30
  s_waitcnt lgkmcnt(0)
  v_writelane_b32 v115, s35, 0
  v_writelane_b32 v115, s39, 1
  v_writelane_b32 v115, s43, 2
  v_writelane_b32 v115, s47, 3
  v_writelane_b32 v115, s51, 4
  v_writelane_b32 v115, s55, 5
  v_writelane_b32 v115, s59, 6
  v_writelane_b32 v115, s63, 7
  v_writelane_b32 v115, s67, 8
  v_writelane_b32 v115, s71, 9
  v_writelane_b32 v115, s75, 10
  v_writelane_b32 v115, s79, 11
  v_writelane_b32 v115, s83, 12
  v_writelane_b32 v115, s87, 13
  v_writelane_b32 v115, s91, 14
  v_writelane_b32 v115, s95, 15
  v_cmp_ne_u32 vcc, s30, v115
  s_cmp_eq_u64 vcc, 0
  s_cbranch_scc1 L_qb_ok
  s_add_u32 s14, s14, 0x3000
  s_load_dwordx16 s[32:47], s[28:29], s14 offset:0
  s_load_dwordx16 s[48:63], s[28:29], s14 offset:64
  s_load_dwordx16 s[64:79], s[28:29], s14 offset:128
  s_load_dwordx16 s[80:95], s[28:29], s14 offset:192
  v_mov_b32 v115, s30
  s_waitcnt lgkmcnt(0)
  v_writelane_b32 v115, s35, 0
  v_writelane_b32 v115, s39, 1
  v_writelane_b32 v115, s43, 2
  v_writelane_b32 v115, s47, 3
  v_writelane_b32 v115, s51, 4
  v_writelane_b32 v115, s55, 5
  v_writelane_b32 v115, s59, 6
  v_writelane_b32 v115, s63, 7
  v_writelane_b32 v115, s67, 8
  v_writelane_b32 v115, s71, 9
  v_writelane_b32 v115, s75, 10
  v_writelane_b32 v115, s79, 11
  v_writelane_b32 v115, s83, 12
  v_writelane_b32 v115, s87, 13
  v_writelane_b32 v115, s91, 14
  v_writelane_b32 v115, s95, 15
  v_cmp_ne_u32 vcc, s30, v115
  s_cmp_eq_u64 vcc, 0
  s_cbranch_scc1 L_qb_ok
  s_add_u32 s14, s14, 0x2000
  s_sleep 2
  s_load_dwordx16 s[32:47], s[28:29], s14 offset:0
  s_load_dwordx16 s[48:63], s[28:29], s14 offset:64
  s_load_dwordx16 s[64:79], s[28:29], s14 offset:128
  s_load_dwordx16 s[80:95], s[28:29], s14 offset:192
  v_mov_b32 v115, s30
  s_waitcnt lgkmcnt(0)
  v_writelane_b32 v115, s35, 0
  v_writelane_b32 v115, s39, 1
  v_writelane_b32 v115, s43, 2
  v_writelane_b32 v115, s47, 3
  v_writelane_b32 v115, s51, 4
  v_writelane_b32 v115, s55, 5
  v_writelane_b32 v115, s59, 6
  v_writelane_b32 v115, s63, 7
  v_writelane_b32 v115, s67, 8
  v_writelane_b32 v115, s71, 9
  v_writelane_b32 v115, s75, 10
  v_writelane_b32 v115, s79, 11
  v_writelane_b32 v115, s83, 12
  v_writelane_b32 v115, s87, 13
  v_writelane_b32 v115, s91, 14
  v_writelane_b32 v115, s95, 15
  v_cmp_ne_u32 vcc, s30, v115
  s_cmp_eq_u64 vcc, 0
  s_cbranch_scc0 L_qb_slow
L_qb_ok:
  v_writelane_b32 v112, s32, 0
  v_writelane_b32 v112, s36, 1
  v_writelane_b32 v112, s40, 2
  v_writelane_b32 v112, s44, 3
  v_writelane_b32 v112, s48, 4
  v_writelane_b32 v112, s52, 5
  v_writelane_b32 v112, s56, 6
  v_writelane_b32 v112, s60, 7
  v_writelane_b32 v112, s64, 8
  v_writelane_b32 v112, s68, 9
  v_writelane_b32 v112, s72, 10
  v_writelane_b32 v112, s76, 11
  v_writelane_b32 v112, s80, 12
  v_writelane_b32 v112, s84, 13
  v_writelane_b32 v112, s88, 14
  v_writelane_b32 v112, s92, 15
  v_writelane_b32 v113, s33, 0
  v_writelane_b32 v113, s37, 1
  v_writelane_b32 v113, s41, 2
  v_writelane_b32 v113, s45, 3
  v_writelane_b32 v113, s49, 4
  v_writelane_b32 v113, s53, 5
  v_writelane_b32 v113, s57, 6
  v_writelane_b32 v113, s61, 7
  v_writelane_b32 v113, s65, 8
  v_writelane_b32 v113, s69, 9
  v_writelane_b32 v113, s73, 10
  v_writelane_b32 v113, s77, 11
  v_writelane_b32 v113, s81, 12
  v_writelane_b32 v113, s85, 13
  v_writelane_b32 v113, s89, 14
  v_writelane_b32 v113, s93, 15
  v_writelane_b32 v114, s34, 0
  v_writelane_b32 v114, s38, 1
  v_writelane_b32 v114, s42, 2
  v_writelane_b32 v114, s46, 3
  v_writelane_b32 v114, s50, 4
  v_writelane_b32 v114, s54, 5
  v_writelane_b32 v114, s58, 6
  v_writelane_b32 v114, s62, 7
  v_writelane_b32 v114, s66, 8
  v_writelane_b32 v114, s70, 9
  v_writelane_b32 v114, s74, 10
  v_writelane_b32 v114, s78, 11
  v_writelane_b32 v114, s82, 12
  v_writelane_b32 v114, s86, 13
  v_writelane_b32 v114, s90, 14
  v_writelane_b32 v114, s94, 15
L_qb_put:
  s_mov_b32 exec_lo, 0xffff
  s_mov_b32 exec_hi, 0
  ds_write_b128 v116, v[112:115] offset:1024
  s_mov_b64 exec, -1
  s_cmp_lg_u32 s11, 0
  s_cbranch_scc1 L_qb_cnt
  s_movk_i32 s11, 0x100
  s_add_u32 s8, s8, s11
  s_add_u32 s9, s9, s11
  v_add_u32 v116, s11, v116
  s_cmp_lg_u32 s15, 0
  s_cbranch_scc1 L_qb_fast
  s_branch L_qb_slow
L_qb_cnt:
  s_mov_b64 exec, 1
  ds_add_rtn_u32 v13, v10, v11 offset:12
  s_mov_b64 exec, -1
  s_waitcnt lgkmcnt(0)
  v_readfirstlane_b32 s101, v13
  s_cmp_lg_u32 s101, 6
  s_cbranch_scc1 L_tk_done
  s_mov_b32 exec_lo, -1
  s_mov_b32 exec_hi, 0xffff
  ds_read_b96 v[100:102], v117 offset:1024
  ds_read_b96 v[104:106], v117 offset:1792
  ds_read_b96 v[108:110], v117 offset:2560
  ds_read_b96 v[112:114], v117 offset:3328
  s_mov_b32 s14, 0x0c04000c
  s_mov_b32 s15, 0x0402010c
  v_lshrrev_b32 v13, 1, v117
  s_waitcnt lgkmcnt(3)
  v_perm_b32 v103, v101, v100, s14
  v_and_b32 v100, 0xffffff00, v100
  v_and_b32 v101, 0xffffff00, v101
  v_perm_b32 v103, v102, v103, s15
  v_and_b32 v102, 0xffffff00, v102
  s_waitcnt lgkmcnt(2)
  v_perm_b32 v107, v105, v104, s14
  v_and_b32 v104, 0xffffff00, v104
  v_and_b32 v105, 0xffffff00, v105
  v_perm_b32 v107, v106, v107, s15
  v_and_b32 v106, 0xffffff00, v106
  v_pk_add_f32 v[100:101], v[100:101], v[104:105]
  v_pk_add_f32 v[102:103], v[102:103], v[106:107]
  s_waitcnt lgkmcnt(1)
  v_perm_b32 v111, v109, v108, s14
  v_and_b32 v108, 0xffffff00, v108
  v_and_b32 v109, 0xffffff00, v109
  v_perm_b32 v111, v110, v111, s15
  v_and_b32 v110, 0xffffff00, v110
  s_waitcnt lgkmcnt(0)
  v_perm_b32 v115, v113, v112, s14
  v_and_b32 v112, 0xffffff00, v112
  v_and_b32 v113, 0xffffff00, v113
  v_perm_b32 v115, v114, v115, s15
  v_and_b32 v114, 0xffffff00, v114
  v_pk_add_f32 v[108:109], v[108:109], v[112:113]
  v_pk_add_f32 v[110:111], v[110:111], v[114:115]
  v_pk_add_f32 v[100:101], v[100:101], v[108:109]
  v_pk_add_f32 v[102:103], v[102:103], v[110:111]
  v_cvt_pk_bf16_f32 v112, v100, v101
  v_cvt_pk_bf16_f32 v113, v102, v103
  ds_write_b64 v13, v[112:113] offset:512
  s_mov_b64 exec, 1
  ds_add_u32 v10, v11 offset:16
  s_mov_b64 exec, -1
L_tk_done:
  s_cmp_ge_u32 s3, 4
  s_cbranch_scc1 L_v2
  s_cmp_eq_u32 s99, 3
  s_cbranch_scc1 L_end
  s_setprio 0
  s_mov_b32 s14, s3
L_wo:
  s_mov_b32 s16, s12
  s_and_b32 s17, s13, 0xffff
  s_mov_b32 s18, 7864320
  s_mov_b32 s19, 0x20000
  v_lshrrev_b32 v3, 4, v2
  v_and_b32 v4, 15, v2
  v_mul_u32_u24 v6, 20480, v3
  v_lshl_add_u32 v6, v4, 4, v6
  s_mul_i32 s40, s98, 192
  s_lshl_b32 s41, s99, 6
  s_add_u32 s40, s40, s41
  s_mul_i32 s40, s40, 1280
  s_lshl_b32 s41, s14, 8
  s_add_u32 s32, s40, s41
  s_add_u32 s33, s32, 3840
  s_add_u32 s34, s33, 3840
  s_add_u32 s35, s34, 3840
  s_add_u32 s36, s35, 3840
  s_add_u32 s37, s36, 3840
  v_and_b32 v96, 1, v4
  v_cmp_eq_u32 vcc, 1, v96
  v_mov_b32 v97, 0x0c0c0100
  v_mov_b32 v98, 0x01000c0c
  v_mov_b32 v99, 0x0c0c0c0c
  v_cndmask_b32 v97, v97, v98, vcc
  v_mov_b32 v98, 0x0c0c0302
  v_mov_b32 v96, 0x03020c0c
  v_cndmask_b32 v98, v98, v96, vcc
  v_lshrrev_b32 v96, 1, v4
  v_cmp_eq_u32 vcc, 0, v96
  s_nop 1
  v_cndmask_b32 v80, v99, v97, vcc
  v_cndmask_b32 v81, v99, v98, vcc
  v_cmp_eq_u32 vcc, 1, v96
  s_nop 1
  v_cndmask_b32 v82, v99, v97, vcc
  v_cndmask_b32 v83, v99, v98, vcc
  v_cmp_eq_u32 vcc, 2, v96
  s_nop 1
  v_cndmask_b32 v84, v99, v97, vcc
  v_cndmask_b32 v85, v99, v98, vcc
  v_cmp_eq_u32 vcc, 3, v96
  s_nop 1
  v_cndmask_b32 v86, v99, v97, vcc
  v_cndmask_b32 v87, v99, v98, vcc
  v_lshlrev_b32 v7, 5, v3
  v_lshlrev_b32 v14, 5, v4
  v_lshl_add_u32 v14, v3, 4, v14
  s_mul_i32 s40, s98, 3
  s_add_u32 s40, s40, s99
  s_mul_i32 s40, s40, 2560
  s_lshl_b32 s41, s14, 9
  s_add_u32 s40, s40, s41
  s_mul_i32 s41, s97, 0x3c000
  s_add_u32 s40, s40, s41
  s_add_u32 s38, s40, 0x281000
  s_mov_b32 s39, 0x07060501
  s_mov_b32 s40, 0x07060502
  s_mov_b32 s41, 0x07060503
  v_mov_b32 v111, s30
L_spin2:
  ds_read_b32 v13, v10 offset:8
  s_waitcnt lgkmcnt(0)
  v_readfirstlane_b32 s101, v13
  s_cmp_ge_u32 s101, 8
  s_cbranch_scc1 L_spin2_done
  s_sub_u32 s100, s100, 1
  s_cbranch_scc1 L_end
  s_sleep 1
  s_branch L_spin2
L_spin2_done:
  s_waitcnt vmcnt(0)
  s_mul_i32 s42, s3, 5120-256
  s_add_u32 s42, s42, s32
  s_add_u32 s42, s42, 1024
  s_add_u32 s43, s42, 3840
  buffer_load_dwordx4 v[112:115], v6, s[16:19], s42 offen offset:0 nt
  buffer_load_dwordx4 v[116:119], v6, s[16:19], s42 offen offset:1280 nt
  buffer_load_dwordx4 v[120:123], v6, s[16:19], s42 offen offset:2560 nt
  buffer_load_dwordx4 v[124:127], v6, s[16:19], s43 offen offset:0 nt
  buffer_load_dwordx4 v[16:19], v6, s[16:19], s32 offen offset:0 nt
  buffer_load_dwordx4 v[20:23], v6, s[16:19], s32 offen offset:1280 nt
  buffer_load_dwordx4 v[24:27], v6, s[16:19], s32 offen offset:2560 nt
  buffer_load_dwordx4 v[28:31], v6, s[16:19], s33 offen offset:0 nt
  buffer_load_dwordx4 v[32:35], v6, s[16:19], s33 offen offset:1280 nt
  buffer_load_dwordx4 v[36:39], v6, s[16:19], s33 offen offset:2560 nt
  buffer_load_dwordx4 v[40:43], v6, s[16:19], s34 offen offset:0 nt
  buffer_load_dwordx4 v[44:47], v6, s[16:19], s34 offen offset:1280 nt
  buffer_load_dwordx4 v[48:51], v6, s[16:19], s34 offen offset:2560 nt
  buffer_load_dwordx4 v[52:55], v6, s[16:19], s35 offen offset:0 nt
  buffer_load_dwordx4 v[56:59], v6, s[16:19], s35 offen offset:1280 nt
  buffer_load_dwordx4 v[60:63], v6, s[16:19], s35 offen offset:2560 nt
  buffer_load_dwordx4 v[64:67], v6, s[16:19], s36 offen offset:0 nt
  buffer_load_dwordx4 v[68:71], v6, s[16:19], s36 offen offset:1280 nt
  buffer_load_dwordx4 v[72:75], v6, s[16:19], s36 offen offset:2560 nt
  buffer_load_dwordx4 v[76:79], v6, s[16:19], s37 offen offset:0 nt
  s_lshl_b32 s42, s3, 3
  v_add_u32 v5, s42, v7
  s_lshl_b32 s42, s3, 9
  v_add_u32 v15, s42, v14
  s_sub_u32 s43, s38, s42
  v_lshlrev_b32 v12, 4, v2
L_spin4:
  ds_read_b32 v13, v10 offset:84
  s_waitcnt lgkmcnt(0)
  v_readfirstlane_b32 s101, v13
  s_cmp_ge_u32 s101, 1
  s_cbranch_scc1 L_spin4_done
  s_sub_u32 s100, s100, 1
  s_cbranch_scc1 L_end
  s_sleep 1
  s_branch L_spin4
L_spin4_done:
  s_mov_b32 s47, s101
L_spin5:
  ds_read_b32 v13, v10 offset:36
  s_waitcnt lgkmcnt(0)
  v_readfirstlane_b32 s101, v13
  s_cmp_ge_u32 s101, 1
  s_cbranch_scc1 L_spin5_done
  s_sub_u32 s100, s100, 1
  s_cbranch_scc1 L_end
  s_sleep 1
  s_branch L_spin5
L_spin5_done:
  s_setprio 3
  ds_read_b64 v[100:101], v5 offset:320
  ds_read_b128 v[88:91], v7 offset:320
  ds_read_b128 v[92:95], v7 offset:336
  s_waitcnt lgkmcnt(2)
  v_perm_b32 v96, v100, v100, v80
  v_perm_b32 v97, v100, v100, v82
  v_perm_b32 v98, v100, v100, v84
  v_perm_b32 v99, v100, v100, v86
  s_waitcnt vmcnt(19)
  s_nop 0
  v_mfma_f32_16x16x32_bf16 v[108:111], v[96:99], v[112:115], 0
  s_nop 3
  v_perm_b32 v96, v100, v100, v81
  v_perm_b32 v97, v100, v100, v83
  v_perm_b32 v98, v100, v100, v85
  v_perm_b32 v99, v100, v100, v87
  s_waitcnt vmcnt(18)
  s_nop 0
  v_mfma_f32_16x16x32_bf16 v[108:111], v[96:99], v[116:119], v[108:111]
  s_nop 3
  v_perm_b32 v96, v101, v101, v80
  v_perm_b32 v97, v101, v101, v82
  v_perm_b32 v98, v101, v101, v84
  v_perm_b32 v99, v101, v101, v86
  s_waitcnt vmcnt(17)
  s_nop 0
  v_mfma_f32_16x16x32_bf16 v[108:111], v[96:99], v[120:123], v[108:111]
  s_nop 3
  v_perm_b32 v96, v101, v101, v81
  v_perm_b32 v97, v101, v101, v83
  v_perm_b32 v98, v101, v101, v85
  v_perm_b32 v99, v101, v101, v87
  s_waitcnt vmcnt(16)
  s_nop 0
  v_mfma_f32_16x16x32_bf16 v[108:111], v[96:99], v[124:127], v[108:111]
  s_nop 3
  s_waitcnt lgkmcnt(0)
  v_perm_b32 v96, v88, v88, v80
  v_perm_b32 v97, v88, v88, v82
  v_perm_b32 v98, v88, v88, v84
  v_perm_b32 v99, v88, v88, v86
  v_perm_b32 v100, v88, v88, v81
  v_perm_b32 v101, v88, v88, v83
  v_perm_b32 v102, v88, v88, v85
  v_perm_b32 v103, v88, v88, v87
  s_nop 0
  s_waitcnt vmcnt(15)
  v_mfma_f32_16x16x32_bf16 v[104:107], v[96:99], v[16:19], 0
  v_perm_b32 v96, v89, v89, v80
  v_perm_b32 v97, v89, v89, v82
  v_perm_b32 v98, v89, v89, v84
  v_perm_b32 v99, v89, v89, v86
  s_nop 0
  s_waitcnt vmcnt(14)
  v_mfma_f32_16x16x32_bf16 v[104:107], v[100:103], v[20:23], v[104:107]
  v_perm_b32 v100, v89, v89, v81
  v_perm_b32 v101, v89, v89, v83
  v_perm_b32 v102, v89, v89, v85
  v_perm_b32 v103, v89, v89, v87
  s_mov_b32 exec_hi, 0
  ds_write_b128 v15, v[108:111] offset:1024
  s_mov_b64 exec, 1
  ds_add_u32 v10, v11 offset:44
  s_mov_b64 exec, -1
  s_waitcnt vmcnt(13)
  v_mfma_f32_16x16x32_bf16 v[104:107], v[96:99], v[24:27], v[104:107]
  v_perm_b32 v96, v90, v90, v80
  v_perm_b32 v97, v90, v90, v82
  v_perm_b32 v98, v90, v90, v84
  v_perm_b32 v99, v90, v90, v86
  s_mov_b32 s14, s3
  s_waitcnt vmcnt(12)
  v_mfma_f32_16x16x32_bf16 v[104:107], v[100:103], v[28:31], v[104:107]
  v_perm_b32 v100, v90, v90, v81
  v_perm_b32 v101, v90, v90, v83
  v_perm_b32 v102, v90, v90, v85
  v_perm_b32 v103, v90, v90, v87
  s_mul_i32 s45, s97, 20480
  s_mul_i32 s48, s14, 4096
  s_add_u32 s45, s45, s48
  s_waitcnt vmcnt(11)
  v_mfma_f32_16x16x32_bf16 v[104:107], v[96:99], v[32:35], v[104:107]
  v_perm_b32 v96, v91, v91, v80
  v_perm_b32 v97, v91, v91, v82
  v_perm_b32 v98, v91, v91, v84
  v_perm_b32 v99, v91, v91, v86
  s_add_u32 s45, s45, 0x401000
  s_add_u32 s48, s45, 2048
  s_waitcnt vmcnt(10)
  v_mfma_f32_16x16x32_bf16 v[104:107], v[100:103], v[36:39], v[104:107]
  v_perm_b32 v100, v91, v91, v81
  v_perm_b32 v101, v91, v91, v83
  v_perm_b32 v102, v91, v91, v85
  v_perm_b32 v103, v91, v91, v87
  s_mov_b32 s46, 0
  s_mov_b32 s54, 0x2000000
  s_sub_u32 s56, s54, s47
  s_sub_u32 s57, s47, 0x20000
  s_waitcnt vmcnt(9)
  v_mfma_f32_16x16x32_bf16 v[104:107], v[96:99], v[40:43], v[104:107]
  v_perm_b32 v96, v92, v92, v80
  v_perm_b32 v97, v92, v92, v82
  v_perm_b32 v98, v92, v92, v84
  v_perm_b32 v99, v92, v92, v86
  s_lshr_b32 s55, s47, 20
  s_sub_i32 s55, s55, 906
  s_max_i32 s55, s55, 0
  s_min_i32 s55, s55, 255
  s_lshl_b32 s55, s55, 23
  s_waitcnt vmcnt(8)
  v_mfma_f32_16x16x32_bf16 v[104:107], v[100:103], v[44:47], v[104:107]
  v_perm_b32 v100, v92, v92, v81
  v_perm_b32 v101, v92, v92, v83
  v_perm_b32 v102, v92, v92, v85
  v_perm_b32 v103, v92, v92, v87
  s_mul_i32 s49, s97, 1280
  s_lshl_b32 s50, s14, 8
  s_add_u32 s49, s49, s50
  s_waitcnt vmcnt(7)
  v_mfma_f32_16x16x32_bf16 v[104:107], v[96:99], v[48:51], v[104:107]
  v_perm_b32 v96, v93, v93, v80
  v_perm_b32 v97, v93, v93, v82
  v_perm_b32 v98, v93, v93, v84
  v_perm_b32 v99, v93, v93, v86
  v_lshrrev_b32 v120, 3, v2
  v_and_b32 v121, 7, v2
  s_waitcnt vmcnt(6)
  v_mfma_f32_16x16x32_bf16 v[104:107], v[100:103], v[52:55], v[104:107]
  v_perm_b32 v100, v93, v93, v81
  v_perm_b32 v101, v93, v93, v83
  v_perm_b32 v102, v93, v93, v85
  v_perm_b32 v103, v93, v93, v87
  v_mul_u32_u24 v120, 256, v120
  v_and_b32 v123, 15, v2
  s_waitcnt vmcnt(5)
  v_mfma_f32_16x16x32_bf16 v[104:107], v[96:99], v[56:59], v[104:107]
  v_perm_b32 v96, v94, v94, v80
  v_perm_b32 v97, v94, v94, v82
  v_perm_b32 v98, v94, v94, v84
  v_perm_b32 v99, v94, v94, v86
  v_lshl_add_u32 v120, v121, 3, v120
  v_bfe_u32 v121, v2, 4, 1
  v_lshlrev_b32 v123, 4, v123
  s_waitcnt vmcnt(4)
  v_mfma_f32_16x16x32_bf16 v[104:107], v[100:103], v[60:63], v[104:107]
  v_perm_b32 v100, v94, v94, v81
  v_perm_b32 v101, v94, v94, v83
  v_perm_b32 v102, v94, v94, v85
  v_perm_b32 v103, v94, v94, v87
  v_lshl_add_u32 v123, v121, 3, v123
  v_lshrrev_b32 v122, 5, v2
  s_waitcnt vmcnt(3)
  v_mfma_f32_16x16x32_bf16 v[104:107], v[96:99], v[64:67], v[104:107]
  v_perm_b32 v96, v95, v95, v80
  v_perm_b32 v97, v95, v95, v82
  v_perm_b32 v98, v95, v95, v84
  v_perm_b32 v99, v95, v95, v86
  v_lshl_add_u32 v121, v122, 2, v123
  s_waitcnt vmcnt(2)
  v_mfma_f32_16x16x32_bf16 v[104:107], v[100:103], v[68:71], v[104:107]
  v_perm_b32 v100, v95, v95, v81
  v_perm_b32 v101, v95, v95, v83
  v_perm_b32 v102, v95, v95, v85
  v_perm_b32 v103, v95, v95, v87
  s_mov_b32 s16, s24
  s_and_b32 s17, s25, 0xffff
  s_mov_b32 s18, 2560
  s_mov_b32 s19, 0x20000
  s_waitcnt vmcnt(1)
  v_mfma_f32_16x16x32_bf16 v[104:107], v[96:99], v[72:75], v[104:107]
  s_nop 0
  s_waitcnt vmcnt(0)
  v_mfma_f32_16x16x32_bf16 v[104:107], v[100:103], v[76:79], v[104:107]
  s_nop 7
L_bat:
  v_permlane32_swap_b32 v104, v106
  v_permlane32_swap_b32 v105, v107
  s_nop 0
  v_cvt_f64_f32 v[112:113], v104
  v_cvt_f64_f32 v[114:115], v105
  v_cmp_nlt_f32 s[50:51], |v104|, s55
  v_cmp_nlt_f32 s[52:53], |v105|, s55
  v_add_f64 v[112:113], v[112:113], s[46:47]
  v_add_f64 v[114:115], v[114:115], s[46:47]
  s_or_b64 vcc, s[50:51], s[52:53]
  v_add_u32 v113, s56, v113
  v_add_u32 v115, s56, v115
  s_cbranch_scc1 L_big
L_bat2:
  v_mov_b64 v[116:117], v[112:113]
  v_mov_b64 v[118:119], v[114:115]
  buffer_atomic_add_x2 v[116:117], v120, s[20:23], s45 offen sc0
  buffer_atomic_add_x2 v[118:119], v120, s[20:23], s48 offen sc0
  s_waitcnt vmcnt(0)
  v_add_co_u32 v116, vcc, v116, v112
  v_add_co_u32 v118, s[52:53], v118, v114
  v_addc_co_u32 v117, vcc, v117, v113, vcc
  s_nop 0
  v_addc_co_u32 v119, s[52:53], v119, v115, s[52:53]
  v_add_u32 v112, 0x40020000, v117
  v_add_u32 v114, 0x40020000, v119
  v_and_b32 v117, 0x3ffff, v112
  v_and_b32 v119, 0x3ffff, v114
  v_cmp_gt_u32 s[50:51], s54, v112
  v_cmp_gt_u32 s[52:53], s54, v114
  v_add_u32 v117, s57, v117
  v_add_u32 v119, s57, v119
  s_or_b64 vcc, s[50:51], s[52:53]
  s_cbranch_scc0 L_wo_end
  v_add_f64 v[116:117], v[116:117], -s[46:47]
  v_add_f64 v[118:119], v[118:119], -s[46:47]
  v_cmp_le_u32 vcc, 0x40000, v112
  s_and_b64 s[58:59], vcc, s[50:51]
  v_cmp_le_u32 vcc, 0x40000, v114
  s_and_b64 s[60:61], vcc, s[52:53]
  s_or_b64 vcc, s[58:59], s[60:61]
  s_cbranch_scc1 L_side
L_bat3:
  v_cvt_f32_f64 v116, v[116:117]
  v_cvt_f32_f64 v118, v[118:119]
  s_mov_b64 exec, s[50:51]
  v_cvt_pk_bf16_f32 v116, v116, v116
  buffer_store_short v116, v121, s[16:19], s49 offen nt
  s_mov_b64 exec, s[52:53]
  v_cvt_pk_bf16_f32 v118, v118, v118
  buffer_store_short v118, v121, s[16:19], s49 offen offset:2 nt
  s_mov_b64 exec, -1
  s_cmp_lg_u32 s14, 0
  s_cbranch_scc1 L_wo_end
  s_bitcmp0_b32 s50, 0
  s_cbranch_scc1 L_wo_end
  s_add_u32 s2, s2, 0x85ebca6a
  s_sub_u32 s15, s30, s2
  v_mov_b32 v20, s15
  v_mov_b32 v21, s2
  s_lshl_b32 s14, s97, 8
  s_mov_b64 exec, 1
  buffer_store_dword v20, v10, s[20:23], s14 offen nt
  s_add_u32 s14, s14, 0x900000
  buffer_store_dword v21, v10, s[20:23], s14 offen nt
L_wo_end:
  s_mov_b64 exec, -1
  s_branch L_end
L_big:
  s_mul_i32 s58, s97, 0x80000
  s_lshl_b32 s59, s14, 10
  s_add_u32 s58, s58, s59
  s_add_u32 s58, s58, 0x800000
  v_lshlrev_b32 v122, 3, v2
  s_mul_i32 s59, s98, 3
  s_add_u32 s59, s59, s99
  s_mul_i32 s59, s59, 5120
  s_add_u32 s58, s58, s59
  v_mov_b32 v124, v104
  v_mov_b32 v125, s30
  v_mov_b32 v126, v105
  v_mov_b32 v127, s30
  s_mov_b64 exec, s[50:51]
  buffer_store_dwordx2 v[124:125], v122, s[20:23], s58 offen sc0 sc1
  v_mov_b32 v112, 0
  v_mov_b32 v113, 0x2040000
  s_mov_b64 exec, s[52:53]
  buffer_store_dwordx2 v[126:127], v122, s[20:23], s58 offen offset:512 sc0 sc1
  v_mov_b32 v114, 0
  v_mov_b32 v115, 0x2040000
  s_mov_b64 exec, -1
  s_waitcnt vmcnt(0)
  s_branch L_bat2
L_side:
  s_mov_b64 s[62:63], s[58:59]
  s_mul_i32 s58, s97, 0x80000
  s_lshl_b32 s59, s14, 10
  s_add_u32 s58, s58, s59
  s_add_u32 s58, s58, 0x800000
  v_lshlrev_b32 v122, 3, v2
  s_movk_i32 s59, 96
L_side1:
  buffer_load_dwordx2 v[124:125], v122, s[20:23], s58 offen sc0 sc1
  buffer_load_dwordx2 v[126:127], v122, s[20:23], s58 offen offset:512 sc0 sc1
  s_waitcnt vmcnt(0)
  v_cmp_eq_u32 vcc, s30, v125
  v_cvt_f64_f32 v[124:125], v124
  s_and_b64 exec, vcc, s[62:63]
  v_add_f64 v[116:117], v[116:117], v[124:125]
  s_mov_b64 exec, -1
  v_cmp_eq_u32 vcc, s30, v127
  v_cvt_f64_f32 v[126:127], v126
  s_and_b64 exec, vcc, s[60:61]
  v_add_f64 v[118:119], v[118:119], v[126:127]
  s_mov_b64 exec, -1
  s_add_u32 s58, s58, 5120
  s_sub_u32 s59, s59, 1
  s_cmp_lg_u32 s59, 0
  s_cbranch_scc1 L_side1
  s_branch L_bat3
L_nw:
  s_cmp_lg_u32 s97, 0
  s_waitcnt lgkmcnt(0)
  s_load_dword s30, s[28:29], s31
  s_load_dword s2, s[28:29], s1
  s_cselect_b64 s[4:5], s[14:15], s[4:5]
  s_cselect_b64 s[6:7], s[16:17], s[6:7]
  s_cselect_b64 s[8:9], s[18:19], s[8:9]
  s_cselect_b64 s[10:11], s[20:21], s[10:11]
  s_cselect_b64 s[12:13], s[22:23], s[12:13]
  s_add_u32 s31, s0, 0x1000
  s_mov_b32 s20, s28
  s_and_b32 s21, s29, 0xffff
  s_mov_b32 s22, 268435456
  s_mov_b32 s23, 0x20000
  s_cmp_ge_u32 s3, 8
  s_cbranch_scc1 L_v
L_k:
  s_lshl_b32 s24, s99, 2
  s_add_u32 s24, s24, s3
  s_sub_u32 s24, s24, 4
  s_mov_b32 s16, s6
  s_and_b32 s17, s7, 0xffff
  s_mov_b32 s18, 50331648
  s_mov_b32 s19, 0x20000
  v_mul_u32_u24 v5, 3072, v3
  v_lshl_add_u32 v5, v4, 4, v5
  s_mul_i32 s14, s24, 24576
  s_mul_i32 s15, s98, 1572864
  s_add_u32 s14, s14, s15
  s_add_u32 s7, s14, 1179648
  s_barrier
  buffer_load_dwordx4 v[16:19], v5, s[16:19], s7 offen offset:0 nt
  buffer_load_dwordx4 v[20:23], v5, s[16:19], s7 offen offset:128 nt
  buffer_load_dwordx4 v[24:27], v5, s[16:19], s7 offen offset:256 nt
L_spin7:
  ds_read_b32 v13, v10 offset:40
  s_waitcnt lgkmcnt(0)
  v_readfirstlane_b32 s101, v13
  s_cmp_ge_u32 s101, 4
  s_cbranch_scc1 L_spin7_done
  s_sub_u32 s100, s100, 1
  s_cbranch_scc1 L_end
  s_branch L_spin7
L_spin7_done:
  buffer_load_dwordx4 v[28:31], v5, s[16:19], s7 offen offset:384 nt
  buffer_load_dwordx4 v[32:35], v5, s[16:19], s7 offen offset:512 nt
  buffer_load_dwordx4 v[36:39], v5, s[16:19], s7 offen offset:640 nt
  buffer_load_dwordx4 v[40:43], v5, s[16:19], s7 offen offset:768 nt
  buffer_load_dwordx4 v[44:47], v5, s[16:19], s7 offen offset:896 nt
L_spin8:
  ds_read_b32 v13, v10 offset:12
  s_waitcnt lgkmcnt(0)
  v_readfirstlane_b32 s101, v13
  s_cmp_ge_u32 s101, 1
  s_cbranch_scc1 L_spin8_done
  s_sub_u32 s100, s100, 1
  s_cbranch_scc1 L_end
  s_branch L_spin8
L_spin8_done:
  buffer_load_dwordx4 v[48:51], v5, s[16:19], s7 offen offset:1024 nt
  buffer_load_dwordx4 v[52:55], v5, s[16:19], s7 offen offset:1152 nt
  buffer_load_dwordx4 v[56:59], v5, s[16:19], s7 offen offset:1280 nt
  buffer_load_dwordx4 v[60:63], v5, s[16:19], s7 offen offset:1408 nt
  buffer_load_dwordx4 v[64:67], v5, s[16:19], s7 offen offset:1536 nt
  buffer_load_dwordx4 v[68:71], v5, s[16:19], s7 offen offset:1664 nt
  buffer_load_dwordx4 v[72:75], v5, s[16:19], s7 offen offset:1792 nt
  buffer_load_dwordx4 v[76:79], v5, s[16:19], s7 offen offset:1920 nt
  buffer_load_dwordx4 v[80:83], v5, s[16:19], s7 offen offset:2048 nt
  buffer_load_dwordx4 v[84:87], v5, s[16:19], s7 offen offset:2176 nt
  buffer_load_dwordx4 v[88:91], v5, s[16:19], s7 offen offset:2304 nt
  buffer_load_dwordx4 v[92:95], v5, s[16:19], s7 offen offset:2432 nt
  buffer_load_dwordx4 v[96:99], v5, s[16:19], s7 offen offset:2560 nt
  buffer_load_dwordx4 v[100:103], v5, s[16:19], s7 offen offset:2688 nt
  buffer_load_dwordx4 v[104:107], v5, s[16:19], s7 offen offset:2816 nt
  buffer_load_dwordx4 v[108:111], v5, s[16:19], s7 offen offset:2944 nt
  s_mov_b64 exec, 1
  ds_add_u32 v10, v11 offset:4
  s_mov_b64 exec, -1
  s_waitcnt lgkmcnt(0)
  s_add_u32 s30, s30, 0x9e3779b9
  s_add_u32 s30, s30, s2
  v_lshlrev_b32 v14, 4, v2
  v_lshlrev_b32 v7, 4, v4
  v_lshl_add_u32 v12, v3, 5, v7
  v_lshrrev_b32 v12, 1, v12
  s_lshl_b32 s14, s3, 7
  v_add_u32 v12, s14, v12
  s_lshl_b32 s14, s99, 10
  s_add_u32 s4, s14, s31
  s_add_u32 s4, s4, 0x1000
  s_lshl_b32 s5, s96, 12
  s_add_u32 s5, s5, s14
  s_add_u32 s5, s5, 0x241000
  s_lshl_b32 s7, s99, 2
  s_add_u32 s7, s7, s31
  s_add_u32 s7, s7, 0x2000
  v_lshlrev_b32 v15, 3, v2
  s_getreg_b32 s11, hwreg(HW_REG_XCC_ID, 0, 4)
  s_add_u32 s11, s11, s30
  s_add_u32 s11, s11, 1
  v_mov_b32 v6, s11
  v_and_b32 v5, 1, v2
  v_cmp_eq_u32 s[40:41], 1, v5
L_spin9:
  ds_read_b32 v13, v10 offset:16
  s_waitcnt lgkmcnt(0)
  v_readfirstlane_b32 s101, v13
  s_cmp_ge_u32 s101, 1
  s_cbranch_scc1 L_spin9_done
  s_sub_u32 s100, s100, 1
  s_cbranch_scc1 L_end
  s_branch L_spin9
L_spin9_done:
  s_setprio 2
  ds_read_b128 v[112:115], v7 offset:512
  ds_read_b128 v[116:119], v7 offset:640
  ds_read_b128 v[120:123], v7 offset:768
  s_waitcnt lgkmcnt(0)
  s_waitcnt vmcnt(21)
  v_dot2_f32_bf16 v2, v16, v112, 0
  v_dot2_f32_bf16 v2, v17, v113, v2
  v_dot2_f32_bf16 v2, v18, v114, v2
  v_dot2_f32_bf16 v2, v19, v115, v2
  v_dot2_f32_bf16 v2, v20, v116, v2
  v_dot2_f32_bf16 v2, v21, v117, v2
  v_dot2_f32_bf16 v2, v22, v118, v2
  v_dot2_f32_bf16 v2, v23, v119, v2
  v_dot2_f32_bf16 v2, v24, v120, v2
  v_dot2_f32_bf16 v2, v25, v121, v2
  v_dot2_f32_bf16 v2, v26, v122, v2
  v_dot2_f32_bf16 v2, v27, v123, v2
  s_waitcnt vmcnt(18)
  v_dot2_f32_bf16 v3, v28, v112, 0
  v_dot2_f32_bf16 v3, v29, v113, v3
  v_dot2_f32_bf16 v3, v30, v114, v3
  v_dot2_f32_bf16 v3, v31, v115, v3
  v_dot2_f32_bf16 v3, v32, v116, v3
  v_dot2_f32_bf16 v3, v33, v117, v3
  v_dot2_f32_bf16 v3, v34, v118, v3
  v_dot2_f32_bf16 v3, v35, v119, v3
  v_dot2_f32_bf16 v3, v36, v120, v3
  v_dot2_f32_bf16 v3, v37, v121, v3
  v_dot2_f32_bf16 v3, v38, v122, v3
  v_dot2_f32_bf16 v3, v39, v123, v3
  s_waitcnt vmcnt(15)
  v_dot2_f32_bf16 v4, v40, v112, 0
  v_dot2_f32_bf16 v4, v41, v113, v4
  v_dot2_f32_bf16 v4, v42, v114, v4
  v_dot2_f32_bf16 v4, v43, v115, v4
  v_dot2_f32_bf16 v4, v44, v116, v4
  v_dot2_f32_bf16 v4, v45, v117, v4
  v_dot2_f32_bf16 v4, v46, v118, v4
  v_dot2_f32_bf16 v4, v47, v119, v4
  v_dot2_f32_bf16 v4, v48, v120, v4
  v_dot2_f32_bf16 v4, v49, v121, v4
  v_dot2_f32_bf16 v4, v50, v122, v4
  v_dot2_f32_bf16 v4, v51, v123, v4
  s_waitcnt vmcnt(12)
  v_dot2_f32_bf16 v5, v52, v112, 0
  v_dot2_f32_bf16 v5, v53, v113, v5
  v_dot2_f32_bf16 v5, v54, v114, v5
  v_dot2_f32_bf16 v5, v55, v115, v5
  v_dot2_f32_bf16 v5, v56, v116, v5
  v_dot2_f32_bf16 v5, v57, v117, v5
  v_dot2_f32_bf16 v5, v58, v118, v5
  v_dot2_f32_bf16 v5, v59, v119, v5
  v_dot2_f32_bf16 v5, v60, v120, v5
  v_dot2_f32_bf16 v5, v61, v121, v5
  v_dot2_f32_bf16 v5, v62, v122, v5
  v_dot2_f32_bf16 v5, v63, v123, v5
  s_nop 2
  v_add_f32_dpp v2, v2, v2 quad_perm:[1,0,3,2] row_mask:0xf bank_mask:0xf
  v_add_f32_dpp v3, v3, v3 quad_perm:[1,0,3,2] row_mask:0xf bank_mask:0xf
  v_add_f32_dpp v4, v4, v4 quad_perm:[1,0,3,2] row_mask:0xf bank_mask:0xf
  v_add_f32_dpp v5, v5, v5 quad_perm:[1,0,3,2] row_mask:0xf bank_mask:0xf
  v_add_f32_dpp v2, v2, v2 quad_perm:[2,3,0,1] row_mask:0xf bank_mask:0xf
  v_add_f32_dpp v3, v3, v3 quad_perm:[2,3,0,1] row_mask:0xf bank_mask:0xf
  v_add_f32_dpp v4, v4, v4 quad_perm:[2,3,0,1] row_mask:0xf bank_mask:0xf
  v_add_f32_dpp v5, v5, v5 quad_perm:[2,3,0,1] row_mask:0xf bank_mask:0xf
  v_add_f32_dpp v2, v2, v2 row_half_mirror row_mask:0xf bank_mask:0xf
  v_add_f32_dpp v3, v3, v3 row_half_mirror row_mask:0xf bank_mask:0xf
  v_add_f32_dpp v4, v4, v4 row_half_mirror row_mask:0xf bank_mask:0xf
  v_add_f32_dpp v5, v5, v5 row_half_mirror row_mask:0xf bank_mask:0xf
  v_cvt_pk_bf16_f32 v20, v2, v3
  v_cvt_pk_bf16_f32 v21, v4, v5
  v_lshlrev_b32 v2, 16, v20
  v_and_b32 v3, 0xffff0000, v20
  v_lshlrev_b32 v4, 16, v21
  v_and_b32 v5, 0xffff0000, v21
  v_mul_f32 v2, 0x3d93cd3a, v2
  v_mul_f32 v3, 0x3d93cd3a, v3
  v_mul_f32 v4, 0x3d93cd3a, v4
  v_mul_f32 v5, 0x3d93cd3a, v5
  v_cvt_pk_bf16_f32 v20, v2, v3
  v_cvt_pk_bf16_f32 v21, v4, v5
  v_mov_b32 v18, s30
  v_mov_b32 v19, s30
  s_waitcnt vmcnt(9)
  v_dot2_f32_bf16 v124, v64, v112, 0
  v_dot2_f32_bf16 v124, v65, v113, v124
  v_dot2_f32_bf16 v124, v66, v114, v124
  v_dot2_f32_bf16 v124, v67, v115, v124
  v_dot2_f32_bf16 v124, v68, v116, v124
  v_dot2_f32_bf16 v124, v69, v117, v124
  v_dot2_f32_bf16 v124, v70, v118, v124
  v_dot2_f32_bf16 v124, v71, v119, v124
  v_dot2_f32_bf16 v124, v72, v120, v124
  v_dot2_f32_bf16 v124, v73, v121, v124
  v_dot2_f32_bf16 v124, v74, v122, v124
  v_dot2_f32_bf16 v124, v75, v123, v124
  s_waitcnt vmcnt(6)
  v_dot2_f32_bf16 v125, v76, v112, 0
  v_dot2_f32_bf16 v125, v77, v113, v125
  v_dot2_f32_bf16 v125, v78, v114, v125
  v_dot2_f32_bf16 v125, v79, v115, v125
  v_dot2_f32_bf16 v125, v80, v116, v125
  v_dot2_f32_bf16 v125, v81, v117, v125
  v_dot2_f32_bf16 v125, v82, v118, v125
  v_dot2_f32_bf16 v125, v83, v119, v125
  v_dot2_f32_bf16 v125, v84, v120, v125
  v_dot2_f32_bf16 v125, v85, v121, v125
  v_dot2_f32_bf16 v125, v86, v122, v125
  v_dot2_f32_bf16 v125, v87, v123, v125
  s_waitcnt vmcnt(3)
  v_dot2_f32_bf16 v126, v88, v112, 0
  v_dot2_f32_bf16 v126, v89, v113, v126
  v_dot2_f32_bf16 v126, v90, v114, v126
  v_dot2_f32_bf16 v126, v91, v115, v126
  v_dot2_f32_bf16 v126, v92, v116, v126
  v_dot2_f32_bf16 v126, v93, v117, v126
  v_dot2_f32_bf16 v126, v94, v118, v126
  v_dot2_f32_bf16 v126, v95, v119, v126
  v_dot2_f32_bf16 v126, v96, v120, v126
  v_dot2_f32_bf16 v126, v97, v121, v126
  v_dot2_f32_bf16 v126, v98, v122, v126
  v_dot2_f32_bf16 v126, v99, v123, v126
  s_waitcnt vmcnt(0)
  v_dot2_f32_bf16 v127, v100, v112, 0
  v_dot2_f32_bf16 v127, v101, v113, v127
  v_dot2_f32_bf16 v127, v102, v114, v127
  v_dot2_f32_bf16 v127, v103, v115, v127
  v_dot2_f32_bf16 v127, v104, v116, v127
  v_dot2_f32_bf16 v127, v105, v117, v127
  v_dot2_f32_bf16 v127, v106, v118, v127
  v_dot2_f32_bf16 v127, v107, v119, v127
  v_dot2_f32_bf16 v127, v108, v120, v127
  v_dot2_f32_bf16 v127, v109, v121, v127
  v_dot2_f32_bf16 v127, v110, v122, v127
  v_dot2_f32_bf16 v127, v111, v123, v127
  s_nop 2
  v_add_f32_dpp v124, v124, v124 quad_perm:[1,0,3,2] row_mask:0xf bank_mask:0xf
  v_add_f32_dpp v125, v125, v125 quad_perm:[1,0,3,2] row_mask:0xf bank_mask:0xf
  v_add_f32_dpp v126, v126, v126 quad_perm:[1,0,3,2] row_mask:0xf bank_mask:0xf
  v_add_f32_dpp v127, v127, v127 quad_perm:[1,0,3,2] row_mask:0xf bank_mask:0xf
  v_add_f32_dpp v124, v124, v124 quad_perm:[2,3,0,1] row_mask:0xf bank_mask:0xf
  v_add_f32_dpp v125, v125, v125 quad_perm:[2,3,0,1] row_mask:0xf bank_mask:0xf
  v_add_f32_dpp v126, v126, v126 quad_perm:[2,3,0,1] row_mask:0xf bank_mask:0xf
  v_add_f32_dpp v127, v127, v127 quad_perm:[2,3,0,1] row_mask:0xf bank_mask:0xf
  v_add_f32_dpp v124, v124, v124 row_half_mirror row_mask:0xf bank_mask:0xf
  v_add_f32_dpp v125, v125, v125 row_half_mirror row_mask:0xf bank_mask:0xf
  v_add_f32_dpp v126, v126, v126 row_half_mirror row_mask:0xf bank_mask:0xf
  v_add_f32_dpp v127, v127, v127 row_half_mirror row_mask:0xf bank_mask:0xf
  v_cvt_pk_bf16_f32 v22, v124, v125
  v_cvt_pk_bf16_f32 v23, v126, v127
  v_lshlrev_b32 v124, 16, v22
  v_and_b32 v125, 0xffff0000, v22
  v_lshlrev_b32 v126, 16, v23
  v_and_b32 v127, 0xffff0000, v23
  v_mul_f32 v124, 0x3d93cd3a, v124
  v_mul_f32 v125, 0x3d93cd3a, v125
  v_mul_f32 v126, 0x3d93cd3a, v126
  v_mul_f32 v127, 0x3d93cd3a, v127
  v_cvt_pk_bf16_f32 v22, v124, v125
  v_cvt_pk_bf16_f32 v23, v126, v127
  v_cndmask_b32 v16, v20, v22, s[40:41]
  v_cndmask_b32 v17, v21, v23, s[40:41]
  s_mov_b32 exec_lo, 0x03030303
  s_mov_b32 exec_hi, 0x03030303
  ds_write_b64 v12, v[16:17] offset:9728
  s_mov_b64 exec, 1
  ds_add_rtn_u32 v13, v10, v11 offset:20
  s_mov_b64 exec, -1
  s_waitcnt lgkmcnt(0)
  v_readfirstlane_b32 s101, v13
  s_cmp_lg_u32 s101, 3
  s_cbranch_scc1 L_chk
  ds_read_b64 v[16:17], v15 offset:10240
  ds_read_b32 v13, v10 offset:64
  s_waitcnt lgkmcnt(1)
  buffer_store_dwordx4 v[16:19], v14, s[20:23], s4 offen
  s_mov_b32 exec_lo, 0xffffffff
  s_mov_b32 exec_hi, 0
  buffer_store_dword v6, v1, s[20:23], s7 offen
  s_mov_b64 exec, -1
  s_add_u32 s4, s4, 0x3000
  buffer_store_dwordx4 v[16:19], v14, s[20:23], s4 offen
  s_add_u32 s4, s4, 0x2000
  buffer_store_dwordx4 v[16:19], v14, s[20:23], s4 offen
  s_waitcnt lgkmcnt(0)
  v_readfirstlane_b32 s101, v13
  s_cmp_eq_u32 s101, 0
  s_cbranch_scc1 L_pp
  buffer_store_dwordx4 v[16:19], v14, s[20:23], s5 offen sc1
L_pp:
  s_mov_b64 exec, 1
  ds_write_b32 v10, v11 offset:68
  s_mov_b64 exec, -1
  s_cmp_eq_u32 s99, 3
  s_cbranch_scc1 L_end
  s_setprio 3
  s_add_u32 s10, s31, 0x2000
  s_lshl_b32 s8, 1, s99
  s_mov_b64 exec, 1
  s_load_dwordx4 s[32:35], s[28:29], s10 offset:0
  s_waitcnt lgkmcnt(0)
  s_cmp_eq_u32 s32, s11
  s_cselect_b32 s32, 1, 0
  s_cmp_eq_u32 s33, s11
  s_cselect_b32 s33, 2, 0
  s_cmp_eq_u32 s34, s11
  s_cselect_b32 s34, 4, 0
  s_cmp_eq_u32 s35, s11
  s_cselect_b32 s35, 8, 0
  s_or_b32 s32, s32, s33
  s_or_b32 s34, s34, s35
  s_or_b32 s8, s8, s32
  s_or_b32 s8, s8, s34
  v_mov_b32 v17, s8
  ds_write_b32 v10, v17 offset:32
  s_cmp_eq_u32 s8, 15
  s_cbranch_scc1 L_pw_done
  s_sleep 1
  s_load_dwordx4 s[32:35], s[28:29], s10 offset:64
  s_waitcnt lgkmcnt(0)
  s_cmp_eq_u32 s32, s11
  s_cselect_b32 s32, 1, 0
  s_cmp_eq_u32 s33, s11
  s_cselect_b32 s33, 2, 0
  s_cmp_eq_u32 s34, s11
  s_cselect_b32 s34, 4, 0
  s_cmp_eq_u32 s35, s11
  s_cselect_b32 s35, 8, 0
  s_or_b32 s32, s32, s33
  s_or_b32 s34, s34, s35
  s_or_b32 s8, s8, s32
  s_or_b32 s8, s8, s34
  v_mov_b32 v17, s8
  ds_write_b32 v10, v17 offset:32
  s_cmp_eq_u32 s8, 15
  s_cbranch_scc1 L_pw_done
  s_sleep 1
  s_load_dwordx4 s[32:35], s[28:29], s10 offset:128
  s_waitcnt lgkmcnt(0)
  s_cmp_eq_u32 s32, s11
  s_cselect_b32 s32, 1, 0
  s_cmp_eq_u32 s33, s11
  s_cselect_b32 s33, 2, 0
  s_cmp_eq_u32 s34, s11
  s_cselect_b32 s34, 4, 0
  s_cmp_eq_u32 s35, s11
  s_cselect_b32 s35, 8, 0
  s_or_b32 s32, s32, s33
  s_or_b32 s34, s34, s35
  s_or_b32 s8, s8, s32
  s_or_b32 s8, s8, s34
  v_mov_b32 v17, s8
  ds_write_b32 v10, v17 offset:32
  s_cmp_eq_u32 s8, 15
  s_cbranch_scc1 L_pw_done
  s_sleep 1
  s_load_dwordx4 s[32:35], s[28:29], s10 offset:192
  s_waitcnt lgkmcnt(0)
  s_cmp_eq_u32 s32, s11
  s_cselect_b32 s32, 1, 0
  s_cmp_eq_u32 s33, s11
  s_cselect_b32 s33, 2, 0
  s_cmp_eq_u32 s34, s11
  s_cselect_b32 s34, 4, 0
  s_cmp_eq_u32 s35, s11
  s_cselect_b32 s35, 8, 0
  s_or_b32 s32, s32, s33
  s_or_b32 s34, s34, s35
  s_or_b32 s8, s8, s32
  s_or_b32 s8, s8, s34
  v_mov_b32 v17, s8
  ds_write_b32 v10, v17 offset:32
  s_cmp_eq_u32 s8, 15
  s_cbranch_scc1 L_pw_done
  s_sleep 1
  s_load_dwordx4 s[32:35], s[28:29], s10 offset:256
  s_waitcnt lgkmcnt(0)
  s_cmp_eq_u32 s32, s11
  s_cselect_b32 s32, 1, 0
  s_cmp_eq_u32 s33, s11
  s_cselect_b32 s33, 2, 0
  s_cmp_eq_u32 s34, s11
  s_cselect_b32 s34, 4, 0
  s_cmp_eq_u32 s35, s11
  s_cselect_b32 s35, 8, 0
  s_or_b32 s32, s32, s33
  s_or_b32 s34, s34, s35
  s_or_b32 s8, s8, s32
  s_or_b32 s8, s8, s34
  v_mov_b32 v17, s8
  ds_write_b32 v10, v17 offset:32
  s_cmp_eq_u32 s8, 15
  s_cbranch_scc1 L_pw_done
  s_sleep 1
  s_load_dwordx4 s[32:35], s[28:29], s10 offset:320
  s_waitcnt lgkmcnt(0)
  s_cmp_eq_u32 s32, s11
  s_cselect_b32 s32, 1, 0
  s_cmp_eq_u32 s33, s11
  s_cselect_b32 s33, 2, 0
  s_cmp_eq_u32 s34, s11
  s_cselect_b32 s34, 4, 0
  s_cmp_eq_u32 s35, s11
  s_cselect_b32 s35, 8, 0
  s_or_b32 s32, s32, s33
  s_or_b32 s34, s34, s35
  s_or_b32 s8, s8, s32
  s_or_b32 s8, s8, s34
  v_mov_b32 v17, s8
  ds_write_b32 v10, v17 offset:32
  s_cmp_eq_u32 s8, 15
  s_cbranch_scc1 L_pw_done
  s_sleep 1
  s_load_dwordx4 s[32:35], s[28:29], s10 offset:384
  s_waitcnt lgkmcnt(0)
  s_cmp_eq_u32 s32, s11
  s_cselect_b32 s32, 1, 0
  s_cmp_eq_u32 s33, s11
  s_cselect_b32 s33, 2, 0
  s_cmp_eq_u32 s34, s11
  s_cselect_b32 s34, 4, 0
  s_cmp_eq_u32 s35, s11
  s_cselect_b32 s35, 8, 0
  s_or_b32 s32, s32, s33
  s_or_b32 s34, s34, s35
  s_or_b32 s8, s8, s32
  s_or_b32 s8, s8, s34
  v_mov_b32 v17, s8
  ds_write_b32 v10, v17 offset:32
  s_cmp_eq_u32 s8, 15
  s_cbranch_scc1 L_pw_done
  s_sleep 1
  s_load_dwordx4 s[32:35], s[28:29], s10 offset:448
  s_waitcnt lgkmcnt(0)
  s_cmp_eq_u32 s32, s11
  s_cselect_b32 s32, 1, 0
  s_cmp_eq_u32 s33, s11
  s_cselect_b32 s33, 2, 0
  s_cmp_eq_u32 s34, s11
  s_cselect_b32 s34, 4, 0
  s_cmp_eq_u32 s35, s11
  s_cselect_b32 s35, 8, 0
  s_or_b32 s32, s32, s33
  s_or_b32 s34, s34, s35
  s_or_b32 s8, s8, s32
  s_or_b32 s8, s8, s34
  v_mov_b32 v17, s8
  ds_write_b32 v10, v17 offset:32
  s_cmp_eq_u32 s8, 15
  s_cbranch_scc1 L_pw_done
  s_sleep 1
  s_load_dwordx4 s[32:35], s[28:29], s10 offset:512
  s_waitcnt lgkmcnt(0)
  s_cmp_eq_u32 s32, s11
  s_cselect_b32 s32, 1, 0
  s_cmp_eq_u32 s33, s11
  s_cselect_b32 s33, 2, 0
  s_cmp_eq_u32 s34, s11
  s_cselect_b32 s34, 4, 0
  s_cmp_eq_u32 s35, s11
  s_cselect_b32 s35, 8, 0
  s_or_b32 s32, s32, s33
  s_or_b32 s34, s34, s35
  s_or_b32 s8, s8, s32
  s_or_b32 s8, s8, s34
  v_mov_b32 v17, s8
  ds_write_b32 v10, v17 offset:32
  s_cmp_eq_u32 s8, 15
  s_cbranch_scc1 L_pw_done
  s_sleep 1
  s_load_dwordx4 s[32:35], s[28:29], s10 offset:576
  s_waitcnt lgkmcnt(0)
  s_cmp_eq_u32 s32, s11
  s_cselect_b32 s32, 1, 0
  s_cmp_eq_u32 s33, s11
  s_cselect_b32 s33, 2, 0
  s_cmp_eq_u32 s34, s11
  s_cselect_b32 s34, 4, 0
  s_cmp_eq_u32 s35, s11
  s_cselect_b32 s35, 8, 0
  s_or_b32 s32, s32, s33
  s_or_b32 s34, s34, s35
  s_or_b32 s8, s8, s32
  s_or_b32 s8, s8, s34
  v_mov_b32 v17, s8
  ds_write_b32 v10, v17 offset:32
  s_cmp_eq_u32 s8, 15
  s_cbranch_scc1 L_pw_done
  s_sleep 1
  s_load_dwordx4 s[32:35], s[28:29], s10 offset:640
  s_waitcnt lgkmcnt(0)
  s_cmp_eq_u32 s32, s11
  s_cselect_b32 s32, 1, 0
  s_cmp_eq_u32 s33, s11
  s_cselect_b32 s33, 2, 0
  s_cmp_eq_u32 s34, s11
  s_cselect_b32 s34, 4, 0
  s_cmp_eq_u32 s35, s11
  s_cselect_b32 s35, 8, 0
  s_or_b32 s32, s32, s33
  s_or_b32 s34, s34, s35
  s_or_b32 s8, s8, s32
  s_or_b32 s8, s8, s34
  v_mov_b32 v17, s8
  ds_write_b32 v10, v17 offset:32
  s_cmp_eq_u32 s8, 15
  s_cbranch_scc1 L_pw_done
  s_sleep 1
  s_load_dwordx4 s[32:35], s[28:29], s10 offset:704
  s_waitcnt lgkmcnt(0)
  s_cmp_eq_u32 s32, s11
  s_cselect_b32 s32, 1, 0
  s_cmp_eq_u32 s33, s11
  s_cselect_b32 s33, 2, 0
  s_cmp_eq_u32 s34, s11
  s_cselect_b32 s34, 4, 0
  s_cmp_eq_u32 s35, s11
  s_cselect_b32 s35, 8, 0
  s_or_b32 s32, s32, s33
  s_or_b32 s34, s34, s35
  s_or_b32 s8, s8, s32
  s_or_b32 s8, s8, s34
  v_mov_b32 v17, s8
  ds_write_b32 v10, v17 offset:32
  s_cmp_eq_u32 s8, 15
  s_cbranch_scc1 L_pw_done
  s_sleep 1
  s_load_dwordx4 s[32:35], s[28:29], s10 offset:768
  s_waitcnt lgkmcnt(0)
  s_cmp_eq_u32 s32, s11
  s_cselect_b32 s32, 1, 0
  s_cmp_eq_u32 s33, s11
  s_cselect_b32 s33, 2, 0
  s_cmp_eq_u32 s34, s11
  s_cselect_b32 s34, 4, 0
  s_cmp_eq_u32 s35, s11
  s_cselect_b32 s35, 8, 0
  s_or_b32 s32, s32, s33
  s_or_b32 s34, s34, s35
  s_or_b32 s8, s8, s32
  s_or_b32 s8, s8, s34
  v_mov_b32 v17, s8
  ds_write_b32 v10, v17 offset:32
  s_cmp_eq_u32 s8, 15
  s_cbranch_scc1 L_pw_done
  s_sleep 1
  s_load_dwordx4 s[32:35], s[28:29], s10 offset:832
  s_waitcnt lgkmcnt(0)
  s_cmp_eq_u32 s32, s11
  s_cselect_b32 s32, 1, 0
  s_cmp_eq_u32 s33, s11
  s_cselect_b32 s33, 2, 0
  s_cmp_eq_u32 s34, s11
  s_cselect_b32 s34, 4, 0
  s_cmp_eq_u32 s35, s11
  s_cselect_b32 s35, 8, 0
  s_or_b32 s32, s32, s33
  s_or_b32 s34, s34, s35
  s_or_b32 s8, s8, s32
  s_or_b32 s8, s8, s34
  v_mov_b32 v17, s8
  ds_write_b32 v10, v17 offset:32
  s_cmp_eq_u32 s8, 15
  s_cbranch_scc1 L_pw_done
  s_sleep 1
  s_load_dwordx4 s[32:35], s[28:29], s10 offset:896
  s_waitcnt lgkmcnt(0)
  s_cmp_eq_u32 s32, s11
  s_cselect_b32 s32, 1, 0
  s_cmp_eq_u32 s33, s11
  s_cselect_b32 s33, 2, 0
  s_cmp_eq_u32 s34, s11
  s_cselect_b32 s34, 4, 0
  s_cmp_eq_u32 s35, s11
  s_cselect_b32 s35, 8, 0
  s_or_b32 s32, s32, s33
  s_or_b32 s34, s34, s35
  s_or_b32 s8, s8, s32
  s_or_b32 s8, s8, s34
  v_mov_b32 v17, s8
  ds_write_b32 v10, v17 offset:32
  s_cmp_eq_u32 s8, 15
  s_cbranch_scc1 L_pw_done
  s_sleep 1
  s_load_dwordx4 s[32:35], s[28:29], s10 offset:960
  s_waitcnt lgkmcnt(0)
  s_cmp_eq_u32 s32, s11
  s_cselect_b32 s32, 1, 0
  s_cmp_eq_u32 s33, s11
  s_cselect_b32 s33, 2, 0
  s_cmp_eq_u32 s34, s11
  s_cselect_b32 s34, 4, 0
  s_cmp_eq_u32 s35, s11
  s_cselect_b32 s35, 8, 0
  s_or_b32 s32, s32, s33
  s_or_b32 s34, s34, s35
  s_or_b32 s8, s8, s32
  s_or_b32 s8, s8, s34
  v_mov_b32 v17, s8
  ds_write_b32 v10, v17 offset:32
  s_cmp_eq_u32 s8, 15
  s_cbranch_scc1 L_pw_done
  s_sleep 1
  s_load_dwordx4 s[32:35], s[28:29], s10 offset:1024
  s_waitcnt lgkmcnt(0)
  s_cmp_eq_u32 s32, s11
  s_cselect_b32 s32, 1, 0
  s_cmp_eq_u32 s33, s11
  s_cselect_b32 s33, 2, 0
  s_cmp_eq_u32 s34, s11
  s_cselect_b32 s34, 4, 0
  s_cmp_eq_u32 s35, s11
  s_cselect_b32 s35, 8, 0
  s_or_b32 s32, s32, s33
  s_or_b32 s34, s34, s35
  s_or_b32 s8, s8, s32
  s_or_b32 s8, s8, s34
  v_mov_b32 v17, s8
  ds_write_b32 v10, v17 offset:32
  s_cmp_eq_u32 s8, 15
  s_cbranch_scc1 L_pw_done
  s_sleep 1
  s_load_dwordx4 s[32:35], s[28:29], s10 offset:1088
  s_waitcnt lgkmcnt(0)
  s_cmp_eq_u32 s32, s11
  s_cselect_b32 s32, 1, 0
  s_cmp_eq_u32 s33, s11
  s_cselect_b32 s33, 2, 0
  s_cmp_eq_u32 s34, s11
  s_cselect_b32 s34, 4, 0
  s_cmp_eq_u32 s35, s11
  s_cselect_b32 s35, 8, 0
  s_or_b32 s32, s32, s33
  s_or_b32 s34, s34, s35
  s_or_b32 s8, s8, s32
  s_or_b32 s8, s8, s34
  v_mov_b32 v17, s8
  ds_write_b32 v10, v17 offset:32
  s_cmp_eq_u32 s8, 15
  s_cbranch_scc1 L_pw_done
  s_sleep 1
  s_load_dwordx4 s[32:35], s[28:29], s10 offset:1152
  s_waitcnt lgkmcnt(0)
  s_cmp_eq_u32 s32, s11
  s_cselect_b32 s32, 1, 0
  s_cmp_eq_u32 s33, s11
  s_cselect_b32 s33, 2, 0
  s_cmp_eq_u32 s34, s11
  s_cselect_b32 s34, 4, 0
  s_cmp_eq_u32 s35, s11
  s_cselect_b32 s35, 8, 0
  s_or_b32 s32, s32, s33
  s_or_b32 s34, s34, s35
  s_or_b32 s8, s8, s32
  s_or_b32 s8, s8, s34
  v_mov_b32 v17, s8
  ds_write_b32 v10, v17 offset:32
  s_cmp_eq_u32 s8, 15
  s_cbranch_scc1 L_pw_done
  s_sleep 1
  s_load_dwordx4 s[32:35], s[28:29], s10 offset:1216
  s_waitcnt lgkmcnt(0)
  s_cmp_eq_u32 s32, s11
  s_cselect_b32 s32, 1, 0
  s_cmp_eq_u32 s33, s11
  s_cselect_b32 s33, 2, 0
  s_cmp_eq_u32 s34, s11
  s_cselect_b32 s34, 4, 0
  s_cmp_eq_u32 s35, s11
  s_cselect_b32 s35, 8, 0
  s_or_b32 s32, s32, s33
  s_or_b32 s34, s34, s35
  s_or_b32 s8, s8, s32
  s_or_b32 s8, s8, s34
  v_mov_b32 v17, s8
  ds_write_b32 v10, v17 offset:32
  s_cmp_eq_u32 s8, 15
  s_cbranch_scc1 L_pw_done
  s_sleep 1
  s_load_dwordx4 s[32:35], s[28:29], s10 offset:1280
  s_waitcnt lgkmcnt(0)
  s_cmp_eq_u32 s32, s11
  s_cselect_b32 s32, 1, 0
  s_cmp_eq_u32 s33, s11
  s_cselect_b32 s33, 2, 0
  s_cmp_eq_u32 s34, s11
  s_cselect_b32 s34, 4, 0
  s_cmp_eq_u32 s35, s11
  s_cselect_b32 s35, 8, 0
  s_or_b32 s32, s32, s33
  s_or_b32 s34, s34, s35
  s_or_b32 s8, s8, s32
  s_or_b32 s8, s8, s34
  v_mov_b32 v17, s8
  ds_write_b32 v10, v17 offset:32
  s_cmp_eq_u32 s8, 15
  s_cbranch_scc1 L_pw_done
  s_sleep 1
  s_load_dwordx4 s[32:35], s[28:29], s10 offset:1344
  s_waitcnt lgkmcnt(0)
  s_cmp_eq_u32 s32, s11
  s_cselect_b32 s32, 1, 0
  s_cmp_eq_u32 s33, s11
  s_cselect_b32 s33, 2, 0
  s_cmp_eq_u32 s34, s11
  s_cselect_b32 s34, 4, 0
  s_cmp_eq_u32 s35, s11
  s_cselect_b32 s35, 8, 0
  s_or_b32 s32, s32, s33
  s_or_b32 s34, s34, s35
  s_or_b32 s8, s8, s32
  s_or_b32 s8, s8, s34
  v_mov_b32 v17, s8
  ds_write_b32 v10, v17 offset:32
  s_cmp_eq_u32 s8, 15
  s_cbranch_scc1 L_pw_done
  s_sleep 1
  s_load_dwordx4 s[32:35], s[28:29], s10 offset:1408
  s_waitcnt lgkmcnt(0)
  s_cmp_eq_u32 s32, s11
  s_cselect_b32 s32, 1, 0
  s_cmp_eq_u32 s33, s11
  s_cselect_b32 s33, 2, 0
  s_cmp_eq_u32 s34, s11
  s_cselect_b32 s34, 4, 0
  s_cmp_eq_u32 s35, s11
  s_cselect_b32 s35, 8, 0
  s_or_b32 s32, s32, s33
  s_or_b32 s34, s34, s35
  s_or_b32 s8, s8, s32
  s_or_b32 s8, s8, s34
  v_mov_b32 v17, s8
  ds_write_b32 v10, v17 offset:32
  s_cmp_eq_u32 s8, 15
  s_cbranch_scc1 L_pw_done
  s_sleep 1
  s_load_dwordx4 s[32:35], s[28:29], s10 offset:1472
  s_waitcnt lgkmcnt(0)
  s_cmp_eq_u32 s32, s11
  s_cselect_b32 s32, 1, 0
  s_cmp_eq_u32 s33, s11
  s_cselect_b32 s33, 2, 0
  s_cmp_eq_u32 s34, s11
  s_cselect_b32 s34, 4, 0
  s_cmp_eq_u32 s35, s11
  s_cselect_b32 s35, 8, 0
  s_or_b32 s32, s32, s33
  s_or_b32 s34, s34, s35
  s_or_b32 s8, s8, s32
  s_or_b32 s8, s8, s34
  v_mov_b32 v17, s8
  ds_write_b32 v10, v17 offset:32
  s_cmp_eq_u32 s8, 15
  s_cbranch_scc1 L_pw_done
  s_sleep 1
  s_load_dwordx4 s[32:35], s[28:29], s10 offset:1536
  s_waitcnt lgkmcnt(0)
  s_cmp_eq_u32 s32, s11
  s_cselect_b32 s32, 1, 0
  s_cmp_eq_u32 s33, s11
  s_cselect_b32 s33, 2, 0
  s_cmp_eq_u32 s34, s11
  s_cselect_b32 s34, 4, 0
  s_cmp_eq_u32 s35, s11
  s_cselect_b32 s35, 8, 0
  s_or_b32 s32, s32, s33
  s_or_b32 s34, s34, s35
  s_or_b32 s8, s8, s32
  s_or_b32 s8, s8, s34
  v_mov_b32 v17, s8
  ds_write_b32 v10, v17 offset:32
  s_cmp_eq_u32 s8, 15
  s_cbranch_scc1 L_pw_done
  s_sleep 1
  s_load_dwordx4 s[32:35], s[28:29], s10 offset:1600
  s_waitcnt lgkmcnt(0)
  s_cmp_eq_u32 s32, s11
  s_cselect_b32 s32, 1, 0
  s_cmp_eq_u32 s33, s11
  s_cselect_b32 s33, 2, 0
  s_cmp_eq_u32 s34, s11
  s_cselect_b32 s34, 4, 0
  s_cmp_eq_u32 s35, s11
  s_cselect_b32 s35, 8, 0
  s_or_b32 s32, s32, s33
  s_or_b32 s34, s34, s35
  s_or_b32 s8, s8, s32
  s_or_b32 s8, s8, s34
  v_mov_b32 v17, s8
  ds_write_b32 v10, v17 offset:32
  s_cmp_eq_u32 s8, 15
  s_cbranch_scc1 L_pw_done
  s_sleep 1
  s_load_dwordx4 s[32:35], s[28:29], s10 offset:1664
  s_waitcnt lgkmcnt(0)
  s_cmp_eq_u32 s32, s11
  s_cselect_b32 s32, 1, 0
  s_cmp_eq_u32 s33, s11
  s_cselect_b32 s33, 2, 0
  s_cmp_eq_u32 s34, s11
  s_cselect_b32 s34, 4, 0
  s_cmp_eq_u32 s35, s11
  s_cselect_b32 s35, 8, 0
  s_or_b32 s32, s32, s33
  s_or_b32 s34, s34, s35
  s_or_b32 s8, s8, s32
  s_or_b32 s8, s8, s34
  v_mov_b32 v17, s8
  ds_write_b32 v10, v17 offset:32
  s_cmp_eq_u32 s8, 15
  s_cbranch_scc1 L_pw_done
  s_sleep 1
  s_load_dwordx4 s[32:35], s[28:29], s10 offset:1728
  s_waitcnt lgkmcnt(0)
  s_cmp_eq_u32 s32, s11
  s_cselect_b32 s32, 1, 0
  s_cmp_eq_u32 s33, s11
  s_cselect_b32 s33, 2, 0
  s_cmp_eq_u32 s34, s11
  s_cselect_b32 s34, 4, 0
  s_cmp_eq_u32 s35, s11
  s_cselect_b32 s35, 8, 0
  s_or_b32 s32, s32, s33
  s_or_b32 s34, s34, s35
  s_or_b32 s8, s8, s32
  s_or_b32 s8, s8, s34
  v_mov_b32 v17, s8
  ds_write_b32 v10, v17 offset:32
  s_cmp_eq_u32 s8, 15
  s_cbranch_scc1 L_pw_done
  s_sleep 1
  s_load_dwordx4 s[32:35], s[28:29], s10 offset:1792
  s_waitcnt lgkmcnt(0)
  s_cmp_eq_u32 s32, s11
  s_cselect_b32 s32, 1, 0
  s_cmp_eq_u32 s33, s11
  s_cselect_b32 s33, 2, 0
  s_cmp_eq_u32 s34, s11
  s_cselect_b32 s34, 4, 0
  s_cmp_eq_u32 s35, s11
  s_cselect_b32 s35, 8, 0
  s_or_b32 s32, s32, s33
  s_or_b32 s34, s34, s35
  s_or_b32 s8, s8, s32
  s_or_b32 s8, s8, s34
  v_mov_b32 v17, s8
  ds_write_b32 v10, v17 offset:32
  s_cmp_eq_u32 s8, 15
  s_cbranch_scc1 L_pw_done
  s_sleep 1
  s_load_dwordx4 s[32:35], s[28:29], s10 offset:1856
  s_waitcnt lgkmcnt(0)
  s_cmp_eq_u32 s32, s11
  s_cselect_b32 s32, 1, 0
  s_cmp_eq_u32 s33, s11
  s_cselect_b32 s33, 2, 0
  s_cmp_eq_u32 s34, s11
  s_cselect_b32 s34, 4, 0
  s_cmp_eq_u32 s35, s11
  s_cselect_b32 s35, 8, 0
  s_or_b32 s32, s32, s33
  s_or_b32 s34, s34, s35
  s_or_b32 s8, s8, s32
  s_or_b32 s8, s8, s34
  v_mov_b32 v17, s8
  ds_write_b32 v10, v17 offset:32
  s_cmp_eq_u32 s8, 15
  s_cbranch_scc1 L_pw_done
  s_sleep 1
  s_load_dwordx4 s[32:35], s[28:29], s10 offset:1920
  s_waitcnt lgkmcnt(0)
  s_cmp_eq_u32 s32, s11
  s_cselect_b32 s32, 1, 0
  s_cmp_eq_u32 s33, s11
  s_cselect_b32 s33, 2, 0
  s_cmp_eq_u32 s34, s11
  s_cselect_b32 s34, 4, 0
  s_cmp_eq_u32 s35, s11
  s_cselect_b32 s35, 8, 0
  s_or_b32 s32, s32, s33
  s_or_b32 s34, s34, s35
  s_or_b32 s8, s8, s32
  s_or_b32 s8, s8, s34
  v_mov_b32 v17, s8
  ds_write_b32 v10, v17 offset:32
  s_cmp_eq_u32 s8, 15
  s_cbranch_scc1 L_pw_done
  s_sleep 1
  s_load_dwordx4 s[32:35], s[28:29], s10 offset:1984
  s_waitcnt lgkmcnt(0)
  s_cmp_eq_u32 s32, s11
  s_cselect_b32 s32, 1, 0
  s_cmp_eq_u32 s33, s11
  s_cselect_b32 s33, 2, 0
  s_cmp_eq_u32 s34, s11
  s_cselect_b32 s34, 4, 0
  s_cmp_eq_u32 s35, s11
  s_cselect_b32 s35, 8, 0
  s_or_b32 s32, s32, s33
  s_or_b32 s34, s34, s35
  s_or_b32 s8, s8, s32
  s_or_b32 s8, s8, s34
  v_mov_b32 v17, s8
  ds_write_b32 v10, v17 offset:32
  s_cmp_eq_u32 s8, 15
  s_cbranch_scc1 L_pw_done
  s_or_b32 s8, s8, 0x10000
  v_mov_b32 v17, s8
  ds_write_b32 v10, v17 offset:32
  s_mov_b64 exec, -1
L_pw_done:
  s_mov_b64 exec, -1
  s_branch L_end
L_chk:
  s_cmp_lg_u32 s101, 0
  s_cbranch_scc1 L_end
  s_cmp_eq_u32 s99, 3
  s_cbranch_scc1 L_end
  s_setprio 0
  s_mov_b32 s32, s8
  s_and_b32 s33, s9, 0xffff
  s_mov_b32 s34, 50331648
  s_mov_b32 s35, 0x20000
  s_mov_b32 s36, s12
  s_and_b32 s37, s13, 0xffff
  s_mov_b32 s38, 7864320
  s_mov_b32 s39, 0x20000
  s_mov_b32 s42, 50330624
  buffer_load_dwordx4 v[24:27], v14, s[32:35], s42 offen
  buffer_load_dwordx4 v[28:31], v14, s[36:39], 0 offen
  v_mul_u32_u24 v22, 64, v14
  s_and_b32 s44, s98, 3
  s_mul_i32 s45, s97, 20
  s_add_u32 s44, s44, s45
  s_lshl_b32 s44, s44, 8
  s_add_u32 s44, s44, 0x3f0000
L_chk1:
  s_mov_b32 exec_lo, 0x1f
  s_mov_b32 exec_hi, 0
  buffer_load_dword v21, v22, s[20:23], s44 offen sc1
  s_waitcnt vmcnt(0)
  v_cmp_ne_u32 vcc, s30, v21
  s_mov_b64 exec, -1
  s_cmp_eq_u64 vcc, 0
  s_cbranch_scc1 L_chk2
  s_sub_u32 s100, s100, 64
  s_cbranch_scc1 L_end
  s_sleep 8
  s_branch L_chk1
L_chk2:
  v_and_b32 v24, 0x7fff7fff, v24
  v_and_b32 v25, 0x7fff7fff, v25
  v_and_b32 v26, 0x7fff7fff, v26
  v_and_b32 v27, 0x7fff7fff, v27
  v_pk_max_u16 v24, v24, v25
  v_pk_max_u16 v26, v26, v27
  v_pk_max_u16 v24, v24, v26
  v_lshrrev_b32 v25, 16, v24
  v_and_b32 v24, 0xffff, v24
  v_max_u32 v24, v24, v25
  v_lshrrev_b32 v24, 7, v24
  v_and_b32 v28, 0x7fff7fff, v28
  v_and_b32 v29, 0x7fff7fff, v29
  v_and_b32 v30, 0x7fff7fff, v30
  v_and_b32 v31, 0x7fff7fff, v31
  v_pk_max_u16 v28, v28, v29
  v_pk_max_u16 v30, v30, v31
  v_pk_max_u16 v28, v28, v30
  v_lshrrev_b32 v29, 16, v28
  v_and_b32 v28, 0xffff, v28
  v_max_u32 v28, v28, v29
  v_lshrrev_b32 v28, 7, v28
  v_lshl_or_b32 v24, v28, 16, v24
  s_nop 1
  v_mov_b32_dpp v25, v24 quad_perm:[1,0,3,2] row_mask:0xf bank_mask:0xf
  v_pk_max_u16 v24, v24, v25
  s_nop 1
  v_mov_b32_dpp v25, v24 quad_perm:[2,3,0,1] row_mask:0xf bank_mask:0xf
  v_pk_max_u16 v24, v24, v25
  s_nop 1
  v_mov_b32_dpp v25, v24 row_half_mirror row_mask:0xf bank_mask:0xf
  v_pk_max_u16 v24, v24, v25
  s_nop 1
  v_mov_b32_dpp v25, v24 row_mirror row_mask:0xf bank_mask:0xf
  v_pk_max_u16 v24, v24, v25
  s_nop 1
  v_readlane_b32 s32, v24, 0
  v_readlane_b32 s33, v24, 16
  v_readlane_b32 s34, v24, 32
  v_readlane_b32 s35, v24, 48
  s_lshr_b32 s36, s32, 16
  s_and_b32 s32, s32, 0xffff
  s_lshr_b32 s37, s33, 16
  s_and_b32 s33, s33, 0xffff
  s_lshr_b32 s38, s34, 16
  s_and_b32 s34, s34, 0xffff
  s_lshr_b32 s39, s35, 16
  s_and_b32 s35, s35, 0xffff
  s_max_u32 s32, s32, s33
  s_max_u32 s36, s36, s37
  s_max_u32 s32, s32, s34
  s_max_u32 s36, s36, s38
  s_max_u32 s32, s32, s35
  s_max_u32 s36, s36, s39
  s_add_u32 s32, s32, s36
  s_add_u32 s32, s32, 789
  s_lshl_b32 s32, s32, 20
  s_or_b32 s32, s32, 0x80000
  v_mov_b32 v21, s32
  s_mov_b64 exec, 1
  ds_write_b32 v10, v21 offset:84
  s_branch L_end
L_v:
  s_cmp_lg_u32 s3, 11
  s_cbranch_scc1 L_noinit
  s_cmp_lg_u32 s99, 3
  s_cbranch_scc1 L_noinit
  s_cmp_gt_u32 s98, 4
  s_cbranch_scc1 L_noinit
  v_lshrrev_b32 v32, 2, v2
  v_and_b32 v33, 3, v2
  v_mul_u32_u24 v32, 256, v32
  v_lshl_add_u32 v32, v33, 4, v32
  v_mov_b32 v16, 0
  v_mov_b32 v17, 0
  v_mov_b32 v18, 0
  v_mov_b32 v19, 0
  s_mul_i32 s44, s97, 5
  s_add_u32 s44, s44, s98
  s_mul_i32 s45, s44, 4096
  s_add_u32 s45, s45, 0x401000
  buffer_store_dwordx4 v[16:19], v32, s[20:23], s45 offen sc0 sc1
  s_barrier
  v_lshrrev_b32 v22, 2, v2
  v_and_b32 v33, 3, v2
  v_lshlrev_b32 v22, 8, v22
  v_lshl_add_u32 v22, v33, 4, v22
  s_mul_i32 s44, s44, 1024
  s_add_u32 s44, s44, 0x3f0000
  s_waitcnt lgkmcnt(0)
  s_add_u32 s30, s30, 0x9e3779b9
  s_add_u32 s30, s30, s2
  v_mov_b32 v24, s30
  v_mov_b32 v25, s30
  v_mov_b32 v26, s30
  v_mov_b32 v27, s30
  s_mov_b32 exec_lo, 0xffff
  s_mov_b32 exec_hi, 0
  s_waitcnt vmcnt(0)
  buffer_store_dwordx4 v[24:27], v22, s[20:23], s44 offen sc0 sc1
  s_branch L_end
L_noinit:
  s_barrier
  s_cmp_lg_u32 s99, 3
  s_cbranch_scc1 L_v1
  s_cmp_ge_u32 s3, 10
  s_cbranch_scc1 L_end
  s_waitcnt lgkmcnt(0)
  s_add_u32 s30, s30, 0x9e3779b9
  s_add_u32 s30, s30, s2
  s_setprio 3
  s_branch L_tk
  s_branch L_end
L_v1:
  s_mov_b32 s16, s8
  s_and_b32 s17, s9, 0xffff
  s_mov_b32 s18, 50331648
  s_mov_b32 s19, 0x20000
  v_mul_u32_u24 v6, 6144, v3
  v_lshl_add_u32 v6, v4, 4, v6
  s_sub_u32 s6, s3, 8
  s_mul_i32 s15, s98, 1572864
  s_mul_i32 s14, s6, 49152
  s_add_u32 s14, s14, 1179648
  s_add_u32 s14, s14, s15
  s_lshl_b32 s15, s99, 7
  s_add_u32 s4, s14, s15
  s_add_u32 s5, s4, 3072
  v_and_b32 v96, 1, v4
  v_cmp_eq_u32 vcc, 1, v96
  v_mov_b32 v97, 0x0c0c0100
  v_mov_b32 v98, 0x01000c0c
  v_mov_b32 v99, 0x0c0c0c0c
  v_cndmask_b32 v97, v97, v98, vcc
  v_mov_b32 v98, 0x0c0c0302
  v_mov_b32 v96, 0x03020c0c
  v_cndmask_b32 v98, v98, v96, vcc
  v_lshrrev_b32 v96, 1, v4
  v_cmp_eq_u32 vcc, 0, v96
  s_nop 1
  v_cndmask_b32 v80, v99, v97, vcc
  v_cndmask_b32 v81, v99, v98, vcc
  v_cmp_eq_u32 vcc, 1, v96
  s_nop 1
  v_cndmask_b32 v82, v99, v97, vcc
  v_cndmask_b32 v83, v99, v98, vcc
  v_cmp_eq_u32 vcc, 2, v96
  s_nop 1
  v_cndmask_b32 v84, v99, v97, vcc
  v_cndmask_b32 v85, v99, v98, vcc
  v_cmp_eq_u32 vcc, 3, v96
  s_nop 1
  v_cndmask_b32 v86, v99, v97, vcc
  v_cndmask_b32 v87, v99, v98, vcc
  v_lshrrev_b32 v14, 5, v2
  v_lshlrev_b32 v14, 8, v14
  v_lshl_add_u32 v14, v4, 5, v14
  v_bfe_u32 v15, v2, 4, 1
  v_lshl_add_u32 v14, v15, 4, v14
  s_lshl_b32 s15, s6, 9
  v_add_u32 v14, s15, v14
  s_lshl_b32 s15, s6, 3
  v_mov_b32 v1, s15
  s_mov_b32 s7, 0x3fb8aa3b
  s_lshl_b32 s14, s6, 9
  s_add_u32 s0, s14, s31
  s_add_u32 s0, s0, 0x1000
  s_lshl_b32 s1, s96, 12
  s_add_u32 s1, s1, s14
  s_add_u32 s1, s1, 0x241000
  s_lshr_b32 s10, s6, 1
  s_and_b32 s14, s6, 1
  s_lshl_b32 s14, s14, 8
  v_lshlrev_b32 v7, 5, v3
  v_add_u32 v7, s14, v7
  s_waitcnt lgkmcnt(0)
  s_add_u32 s30, s30, 0x9e3779b9
  s_add_u32 s30, s30, s2
  s_cmp_ge_u32 s3, 10
  s_cbranch_scc1 L_v3
  s_setprio 3
  s_branch L_tk
L_v2:
  s_setprio 0
  s_cmp_lg_u32 s99, 3
  s_cbranch_scc1 L_v3
  s_branch L_end
L_v3:
L_spin10:
  ds_read_b32 v13, v10 offset:4
  s_waitcnt lgkmcnt(0)
  v_readfirstlane_b32 s101, v13
  s_cmp_ge_u32 s101, 4
  s_cbranch_scc1 L_spin10_done
  s_sub_u32 s100, s100, 1
  s_cbranch_scc1 L_end
  s_sleep 1
  s_branch L_spin10
L_spin10_done:
  buffer_load_dwordx4 v[16:19], v6, s[16:19], s4 offen offset:0 nt
  buffer_load_dwordx4 v[20:23], v6, s[16:19], s4 offen offset:384 nt
  buffer_load_dwordx4 v[24:27], v6, s[16:19], s4 offen offset:768 nt
  buffer_load_dwordx4 v[28:31], v6, s[16:19], s4 offen offset:1152 nt
  buffer_load_dwordx4 v[32:35], v6, s[16:19], s4 offen offset:1536 nt
  buffer_load_dwordx4 v[36:39], v6, s[16:19], s4 offen offset:1920 nt
  buffer_load_dwordx4 v[40:43], v6, s[16:19], s4 offen offset:2304 nt
  buffer_load_dwordx4 v[44:47], v6, s[16:19], s4 offen offset:2688 nt
  ds_read_b32 v13, v10 offset:68
  s_waitcnt lgkmcnt(0)
  v_readfirstlane_b32 s101, v13
  s_cmp_ge_u32 s101, 1
  s_cbranch_scc1 L_pc11_f8
  s_waitcnt vmcnt(7)
  buffer_load_dwordx4 v[48:51], v6, s[16:19], s5 offen offset:0 nt
  ds_read_b32 v13, v10 offset:68
  s_waitcnt lgkmcnt(0)
  v_readfirstlane_b32 s101, v13
  s_cmp_ge_u32 s101, 1
  s_cbranch_scc1 L_pc11_f9
  s_waitcnt vmcnt(7)
  buffer_load_dwordx4 v[52:55], v6, s[16:19], s5 offen offset:384 nt
  ds_read_b32 v13, v10 offset:68
  s_waitcnt lgkmcnt(0)
  v_readfirstlane_b32 s101, v13
  s_cmp_ge_u32 s101, 1
  s_cbranch_scc1 L_pc11_f10
  s_waitcnt vmcnt(7)
  buffer_load_dwordx4 v[56:59], v6, s[16:19], s5 offen offset:768 nt
  ds_read_b32 v13, v10 offset:68
  s_waitcnt lgkmcnt(0)
  v_readfirstlane_b32 s101, v13
  s_cmp_ge_u32 s101, 1
  s_cbranch_scc1 L_pc11_f11
  s_waitcnt vmcnt(7)
  buffer_load_dwordx4 v[60:63], v6, s[16:19], s5 offen offset:1152 nt
  ds_read_b32 v13, v10 offset:68
  s_waitcnt lgkmcnt(0)
  v_readfirstlane_b32 s101, v13
  s_cmp_ge_u32 s101, 1
  s_cbranch_scc1 L_pc11_f12
  s_waitcnt vmcnt(7)
  buffer_load_dwordx4 v[64:67], v6, s[16:19], s5 offen offset:1536 nt
  ds_read_b32 v13, v10 offset:68
  s_waitcnt lgkmcnt(0)
  v_readfirstlane_b32 s101, v13
  s_cmp_ge_u32 s101, 1
  s_cbranch_scc1 L_pc11_f13
  s_waitcnt vmcnt(7)
  buffer_load_dwordx4 v[68:71], v6, s[16:19], s5 offen offset:1920 nt
  ds_read_b32 v13, v10 offset:68
  s_waitcnt lgkmcnt(0)
  v_readfirstlane_b32 s101, v13
  s_cmp_ge_u32 s101, 1
  s_cbranch_scc1 L_pc11_f14
  s_waitcnt vmcnt(7)
  buffer_load_dwordx4 v[72:75], v6, s[16:19], s5 offen offset:2304 nt
  ds_read_b32 v13, v10 offset:68
  s_waitcnt lgkmcnt(0)
  v_readfirstlane_b32 s101, v13
  s_cmp_ge_u32 s101, 1
  s_cbranch_scc1 L_pc11_f15
  s_waitcnt vmcnt(7)
  buffer_load_dwordx4 v[76:79], v6, s[16:19], s5 offen offset:2688 nt
  s_branch L_pc11_done
L_pc11_f8:
  buffer_load_dwordx4 v[48:51], v6, s[16:19], s5 offen offset:0 nt
L_pc11_f9:
  buffer_load_dwordx4 v[52:55], v6, s[16:19], s5 offen offset:384 nt
L_pc11_f10:
  buffer_load_dwordx4 v[56:59], v6, s[16:19], s5 offen offset:768 nt
L_pc11_f11:
  buffer_load_dwordx4 v[60:63], v6, s[16:19], s5 offen offset:1152 nt
L_pc11_f12:
  buffer_load_dwordx4 v[64:67], v6, s[16:19], s5 offen offset:1536 nt
L_pc11_f13:
  buffer_load_dwordx4 v[68:71], v6, s[16:19], s5 offen offset:1920 nt
L_pc11_f14:
  buffer_load_dwordx4 v[72:75], v6, s[16:19], s5 offen offset:2304 nt
L_pc11_f15:
  buffer_load_dwordx4 v[76:79], v6, s[16:19], s5 offen offset:2688 nt
L_pc11_done:
  s_mov_b64 exec, 1
  ds_add_u32 v10, v11 offset:8
  s_mov_b64 exec, -1
  s_setprio 3
  s_cmp_lg_u32 s10, s99
  s_cbranch_scc1 L_vf0
L_spin12:
  ds_read_b32 v13, v10 offset:20
  s_waitcnt lgkmcnt(0)
  v_readfirstlane_b32 s101, v13
  s_cmp_ge_u32 s101, 4
  s_cbranch_scc1 L_spin12_done
  s_sub_u32 s100, s100, 1
  s_cbranch_scc1 L_end
  s_branch L_spin12
L_spin12_done:
  ds_read_b128 v[88:91], v7 offset:10240
  ds_read_b128 v[92:95], v7 offset:10256
  s_waitcnt lgkmcnt(0)
  s_branch L_vs
L_vf0:
  ds_read_b32 v13, v10 offset:32
  s_waitcnt lgkmcnt(0)
  v_readfirstlane_b32 s11, v13
  s_bitcmp1_b32 s11, s10
  s_cbranch_scc1 L_vf0_fast
  s_bitcmp1_b32 s11, 16
  s_cbranch_scc1 L_vf0_slow
  s_sub_u32 s100, s100, 1
  s_cbranch_scc1 L_end
  s_branch L_vf0
L_vf0_fast:
  s_mov_b32 s8, s0
  s_load_dwordx16 s[32:47], s[28:29], s8 offset:0
  s_load_dwordx16 s[48:63], s[28:29], s8 offset:64
  s_load_dwordx16 s[64:79], s[28:29], s8 offset:128
  s_load_dwordx16 s[80:95], s[28:29], s8 offset:192
  v_mov_b32 v112, s30
  s_waitcnt lgkmcnt(0)
  v_writelane_b32 v112, s35, 0
  v_writelane_b32 v112, s39, 1
  v_writelane_b32 v112, s43, 2
  v_writelane_b32 v112, s47, 3
  v_writelane_b32 v112, s51, 4
  v_writelane_b32 v112, s55, 5
  v_writelane_b32 v112, s59, 6
  v_writelane_b32 v112, s63, 7
  v_writelane_b32 v112, s67, 8
  v_writelane_b32 v112, s71, 9
  v_writelane_b32 v112, s75, 10
  v_writelane_b32 v112, s79, 11
  v_writelane_b32 v112, s83, 12
  v_writelane_b32 v112, s87, 13
  v_writelane_b32 v112, s91, 14
  v_writelane_b32 v112, s95, 15
  v_cmp_ne_u32 vcc, s30, v112
  s_cmp_eq_u64 vcc, 0
  s_cbranch_scc1 L_vf0_ok
  s_add_u32 s8, s8, 0x3000
  s_load_dwordx16 s[32:47], s[28:29], s8 offset:0
  s_load_dwordx16 s[48:63], s[28:29], s8 offset:64
  s_load_dwordx16 s[64:79], s[28:29], s8 offset:128
  s_load_dwordx16 s[80:95], s[28:29], s8 offset:192
  v_mov_b32 v112, s30
  s_waitcnt lgkmcnt(0)
  v_writelane_b32 v112, s35, 0
  v_writelane_b32 v112, s39, 1
  v_writelane_b32 v112, s43, 2
  v_writelane_b32 v112, s47, 3
  v_writelane_b32 v112, s51, 4
  v_writelane_b32 v112, s55, 5
  v_writelane_b32 v112, s59, 6
  v_writelane_b32 v112, s63, 7
  v_writelane_b32 v112, s67, 8
  v_writelane_b32 v112, s71, 9
  v_writelane_b32 v112, s75, 10
  v_writelane_b32 v112, s79, 11
  v_writelane_b32 v112, s83, 12
  v_writelane_b32 v112, s87, 13
  v_writelane_b32 v112, s91, 14
  v_writelane_b32 v112, s95, 15
  v_cmp_ne_u32 vcc, s30, v112
  s_cmp_eq_u64 vcc, 0
  s_cbranch_scc1 L_vf0_ok
  s_add_u32 s8, s8, 0x2000
  s_sleep 2
  s_load_dwordx16 s[32:47], s[28:29], s8 offset:0
  s_load_dwordx16 s[48:63], s[28:29], s8 offset:64
  s_load_dwordx16 s[64:79], s[28:29], s8 offset:128
  s_load_dwordx16 s[80:95], s[28:29], s8 offset:192
  v_mov_b32 v112, s30
  s_waitcnt lgkmcnt(0)
  v_writelane_b32 v112, s35, 0
  v_writelane_b32 v112, s39, 1
  v_writelane_b32 v112, s43, 2
  v_writelane_b32 v112, s47, 3
  v_writelane_b32 v112, s51, 4
  v_writelane_b32 v112, s55, 5
  v_writelane_b32 v112, s59, 6
  v_writelane_b32 v112, s63, 7
  v_writelane_b32 v112, s67, 8
  v_writelane_b32 v112, s71, 9
  v_writelane_b32 v112, s75, 10
  v_writelane_b32 v112, s79, 11
  v_writelane_b32 v112, s83, 12
  v_writelane_b32 v112, s87, 13
  v_writelane_b32 v112, s91, 14
  v_writelane_b32 v112, s95, 15
  v_cmp_ne_u32 vcc, s30, v112
  s_cmp_eq_u64 vcc, 0
  s_cbranch_scc1 L_vf0_ok
L_vf0_slow:
  v_lshlrev_b32 v112, 4, v2
  s_sub_u32 s100, s100, 64
  s_cbranch_scc1 L_end
  s_mov_b32 exec_lo, 0xffff
  s_mov_b32 exec_hi, 0
  buffer_load_dwordx4 v[120:123], v112, s[20:23], s0 offen sc1
  buffer_load_dwordx4 v[124:127], v112, s[20:23], s1 offen sc1
  s_waitcnt vmcnt(0)
  v_cmp_eq_u32 vcc, s30, v127
  v_cndmask_b32 v120, v120, v124, vcc
  v_cndmask_b32 v121, v121, v125, vcc
  v_cndmask_b32 v122, v122, v126, vcc
  v_cndmask_b32 v123, v123, v127, vcc
  v_cmp_ne_u32 vcc, s30, v123
  s_mov_b64 exec, -1
  s_cmp_lg_u64 vcc, 0
  s_cbranch_scc1 L_vf0_slow
  v_readlane_b32 s32, v120, 0
  v_readlane_b32 s33, v121, 0
  v_readlane_b32 s34, v122, 0
  v_readlane_b32 s36, v120, 1
  v_readlane_b32 s37, v121, 1
  v_readlane_b32 s38, v122, 1
  v_readlane_b32 s40, v120, 2
  v_readlane_b32 s41, v121, 2
  v_readlane_b32 s42, v122, 2
  v_readlane_b32 s44, v120, 3
  v_readlane_b32 s45, v121, 3
  v_readlane_b32 s46, v122, 3
  v_readlane_b32 s48, v120, 4
  v_readlane_b32 s49, v121, 4
  v_readlane_b32 s50, v122, 4
  v_readlane_b32 s52, v120, 5
  v_readlane_b32 s53, v121, 5
  v_readlane_b32 s54, v122, 5
  v_readlane_b32 s56, v120, 6
  v_readlane_b32 s57, v121, 6
  v_readlane_b32 s58, v122, 6
  v_readlane_b32 s60, v120, 7
  v_readlane_b32 s61, v121, 7
  v_readlane_b32 s62, v122, 7
  v_readlane_b32 s64, v120, 8
  v_readlane_b32 s65, v121, 8
  v_readlane_b32 s66, v122, 8
  v_readlane_b32 s68, v120, 9
  v_readlane_b32 s69, v121, 9
  v_readlane_b32 s70, v122, 9
  v_readlane_b32 s72, v120, 10
  v_readlane_b32 s73, v121, 10
  v_readlane_b32 s74, v122, 10
  v_readlane_b32 s76, v120, 11
  v_readlane_b32 s77, v121, 11
  v_readlane_b32 s78, v122, 11
  v_readlane_b32 s80, v120, 12
  v_readlane_b32 s81, v121, 12
  v_readlane_b32 s82, v122, 12
  v_readlane_b32 s84, v120, 13
  v_readlane_b32 s85, v121, 13
  v_readlane_b32 s86, v122, 13
  v_readlane_b32 s88, v120, 14
  v_readlane_b32 s89, v121, 14
  v_readlane_b32 s90, v122, 14
  v_readlane_b32 s92, v120, 15
  v_readlane_b32 s93, v121, 15
  v_readlane_b32 s94, v122, 15
  s_nop 3
L_vf0_ok:
  s_mov_b32 exec_lo, 0xff
  s_mov_b32 exec_hi, 0
  v_mov_b32 v88, s32
  v_mov_b32 v89, s33
  v_mov_b32 v90, s36
  v_mov_b32 v91, s37
  v_mov_b32 v92, s40
  v_mov_b32 v93, s41
  v_mov_b32 v94, s44
  v_mov_b32 v95, s45
  s_mov_b32 exec_lo, 0xff00
  s_mov_b32 exec_hi, 0
  v_mov_b32 v88, s48
  v_mov_b32 v89, s49
  v_mov_b32 v90, s52
  v_mov_b32 v91, s53
  v_mov_b32 v92, s56
  v_mov_b32 v93, s57
  v_mov_b32 v94, s60
  v_mov_b32 v95, s61
  s_mov_b32 exec_lo, 0xff0000
  s_mov_b32 exec_hi, 0
  v_mov_b32 v88, s64
  v_mov_b32 v89, s65
  v_mov_b32 v90, s68
  v_mov_b32 v91, s69
  v_mov_b32 v92, s72
  v_mov_b32 v93, s73
  v_mov_b32 v94, s76
  v_mov_b32 v95, s77
  s_mov_b32 exec_lo, 0xff000000
  s_mov_b32 exec_hi, 0
  v_mov_b32 v88, s80
  v_mov_b32 v89, s81
  v_mov_b32 v90, s84
  v_mov_b32 v91, s85
  v_mov_b32 v92, s88
  v_mov_b32 v93, s89
  v_mov_b32 v94, s92
  v_mov_b32 v95, s93
  s_mov_b64 exec, -1
  s_add_u32 s0, s0, 256
  s_add_u32 s1, s1, 256
L_vf1:
  s_bitcmp0_b32 s11, s10
  s_cbranch_scc1 L_vf1_slow
L_vf1_fast:
  s_mov_b32 s8, s0
  s_load_dwordx16 s[32:47], s[28:29], s8 offset:0
  s_load_dwordx16 s[48:63], s[28:29], s8 offset:64
  s_load_dwordx16 s[64:79], s[28:29], s8 offset:128
  s_load_dwordx16 s[80:95], s[28:29], s8 offset:192
  v_mov_b32 v112, s30
  s_waitcnt lgkmcnt(0)
  v_writelane_b32 v112, s35, 0
  v_writelane_b32 v112, s39, 1
  v_writelane_b32 v112, s43, 2
  v_writelane_b32 v112, s47, 3
  v_writelane_b32 v112, s51, 4
  v_writelane_b32 v112, s55, 5
  v_writelane_b32 v112, s59, 6
  v_writelane_b32 v112, s63, 7
  v_writelane_b32 v112, s67, 8
  v_writelane_b32 v112, s71, 9
  v_writelane_b32 v112, s75, 10
  v_writelane_b32 v112, s79, 11
  v_writelane_b32 v112, s83, 12
  v_writelane_b32 v112, s87, 13
  v_writelane_b32 v112, s91, 14
  v_writelane_b32 v112, s95, 15
  v_cmp_ne_u32 vcc, s30, v112
  s_cmp_eq_u64 vcc, 0
  s_cbranch_scc1 L_vf1_ok
  s_add_u32 s8, s8, 0x3000
  s_load_dwordx16 s[32:47], s[28:29], s8 offset:0
  s_load_dwordx16 s[48:63], s[28:29], s8 offset:64
  s_load_dwordx16 s[64:79], s[28:29], s8 offset:128
  s_load_dwordx16 s[80:95], s[28:29], s8 offset:192
  v_mov_b32 v112, s30
  s_waitcnt lgkmcnt(0)
  v_writelane_b32 v112, s35, 0
  v_writelane_b32 v112, s39, 1
  v_writelane_b32 v112, s43, 2
  v_writelane_b32 v112, s47, 3
  v_writelane_b32 v112, s51, 4
  v_writelane_b32 v112, s55, 5
  v_writelane_b32 v112, s59, 6
  v_writelane_b32 v112, s63, 7
  v_writelane_b32 v112, s67, 8
  v_writelane_b32 v112, s71, 9
  v_writelane_b32 v112, s75, 10
  v_writelane_b32 v112, s79, 11
  v_writelane_b32 v112, s83, 12
  v_writelane_b32 v112, s87, 13
  v_writelane_b32 v112, s91, 14
  v_writelane_b32 v112, s95, 15
  v_cmp_ne_u32 vcc, s30, v112
  s_cmp_eq_u64 vcc, 0
  s_cbranch_scc1 L_vf1_ok
  s_add_u32 s8, s8, 0x2000
  s_sleep 2
  s_load_dwordx16 s[32:47], s[28:29], s8 offset:0
  s_load_dwordx16 s[48:63], s[28:29], s8 offset:64
  s_load_dwordx16 s[64:79], s[28:29], s8 offset:128
  s_load_dwordx16 s[80:95], s[28:29], s8 offset:192
  v_mov_b32 v112, s30
  s_waitcnt lgkmcnt(0)
  v_writelane_b32 v112, s35, 0
  v_writelane_b32 v112, s39, 1
  v_writelane_b32 v112, s43, 2
  v_writelane_b32 v112, s47, 3
  v_writelane_b32 v112, s51, 4
  v_writelane_b32 v112, s55, 5
  v_writelane_b32 v112, s59, 6
  v_writelane_b32 v112, s63, 7
  v_writelane_b32 v112, s67, 8
  v_writelane_b32 v112, s71, 9
  v_writelane_b32 v112, s75, 10
  v_writelane_b32 v112, s79, 11
  v_writelane_b32 v112, s83, 12
  v_writelane_b32 v112, s87, 13
  v_writelane_b32 v112, s91, 14
  v_writelane_b32 v112, s95, 15
  v_cmp_ne_u32 vcc, s30, v112
  s_cmp_eq_u64 vcc, 0
  s_cbranch_scc1 L_vf1_ok
L_vf1_slow:
  v_lshlrev_b32 v112, 4, v2
  s_sub_u32 s100, s100, 64
  s_cbranch_scc1 L_end
  s_mov_b32 exec_lo, 0xffff
  s_mov_b32 exec_hi, 0
  buffer_load_dwordx4 v[120:123], v112, s[20:23], s0 offen sc1
  buffer_load_dwordx4 v[124:127], v112, s[20:23], s1 offen sc1
  s_waitcnt vmcnt(0)
  v_cmp_eq_u32 vcc, s30, v127
  v_cndmask_b32 v120, v120, v124, vcc
  v_cndmask_b32 v121, v121, v125, vcc
  v_cndmask_b32 v122, v122, v126, vcc
  v_cndmask_b32 v123, v123, v127, vcc
  v_cmp_ne_u32 vcc, s30, v123
  s_mov_b64 exec, -1
  s_cmp_lg_u64 vcc, 0
  s_cbranch_scc1 L_vf1_slow
  v_readlane_b32 s32, v120, 0
  v_readlane_b32 s33, v121, 0
  v_readlane_b32 s34, v122, 0
  v_readlane_b32 s36, v120, 1
  v_readlane_b32 s37, v121, 1
  v_readlane_b32 s38, v122, 1
  v_readlane_b32 s40, v120, 2
  v_readlane_b32 s41, v121, 2
  v_readlane_b32 s42, v122, 2
  v_readlane_b32 s44, v120, 3
  v_readlane_b32 s45, v121, 3
  v_readlane_b32 s46, v122, 3
  v_readlane_b32 s48, v120, 4
  v_readlane_b32 s49, v121, 4
  v_readlane_b32 s50, v122, 4
  v_readlane_b32 s52, v120, 5
  v_readlane_b32 s53, v121, 5
  v_readlane_b32 s54, v122, 5
  v_readlane_b32 s56, v120, 6
  v_readlane_b32 s57, v121, 6
  v_readlane_b32 s58, v122, 6
  v_readlane_b32 s60, v120, 7
  v_readlane_b32 s61, v121, 7
  v_readlane_b32 s62, v122, 7
  v_readlane_b32 s64, v120, 8
  v_readlane_b32 s65, v121, 8
  v_readlane_b32 s66, v122, 8
  v_readlane_b32 s68, v120, 9
  v_readlane_b32 s69, v121, 9
  v_readlane_b32 s70, v122, 9
  v_readlane_b32 s72, v120, 10
  v_readlane_b32 s73, v121, 10
  v_readlane_b32 s74, v122, 10
  v_readlane_b32 s76, v120, 11
  v_readlane_b32 s77, v121, 11
  v_readlane_b32 s78, v122, 11
  v_readlane_b32 s80, v120, 12
  v_readlane_b32 s81, v121, 12
  v_readlane_b32 s82, v122, 12
  v_readlane_b32 s84, v120, 13
  v_readlane_b32 s85, v121, 13
  v_readlane_b32 s86, v122, 13
  v_readlane_b32 s88, v120, 14
  v_readlane_b32 s89, v121, 14
  v_readlane_b32 s90, v122, 14
  v_readlane_b32 s92, v120, 15
  v_readlane_b32 s93, v121, 15
  v_readlane_b32 s94, v122, 15
  s_nop 3
L_vf1_ok:
  s_mov_b32 exec_lo, 0
  s_mov_b32 exec_hi, 0xff
  v_mov_b32 v88, s32
  v_mov_b32 v89, s33
  v_mov_b32 v90, s36
  v_mov_b32 v91, s37
  v_mov_b32 v92, s40
  v_mov_b32 v93, s41
  v_mov_b32 v94, s44
  v_mov_b32 v95, s45
  s_mov_b32 exec_lo, 0
  s_mov_b32 exec_hi, 0xff00
  v_mov_b32 v88, s48
  v_mov_b32 v89, s49
  v_mov_b32 v90, s52
  v_mov_b32 v91, s53
  v_mov_b32 v92, s56
  v_mov_b32 v93, s57
  v_mov_b32 v94, s60
  v_mov_b32 v95, s61
  s_mov_b32 exec_lo, 0
  s_mov_b32 exec_hi, 0xff0000
  v_mov_b32 v88, s64
  v_mov_b32 v89, s65
  v_mov_b32 v90, s68
  v_mov_b32 v91, s69
  v_mov_b32 v92, s72
  v_mov_b32 v93, s73
  v_mov_b32 v94, s76
  v_mov_b32 v95, s77
  s_mov_b32 exec_lo, 0
  s_mov_b32 exec_hi, 0xff000000
  v_mov_b32 v88, s80
  v_mov_b32 v89, s81
  v_mov_b32 v90, s84
  v_mov_b32 v91, s85
  v_mov_b32 v92, s88
  v_mov_b32 v93, s89
  v_mov_b32 v94, s92
  v_mov_b32 v95, s93
  s_mov_b64 exec, -1
L_vs:
  v_lshlrev_b32 v112, 16, v88
  v_and_b32 v113, 0xffff0000, v88
  v_lshlrev_b32 v114, 16, v89
  v_and_b32 v115, 0xffff0000, v89
  v_lshlrev_b32 v116, 16, v90
  v_and_b32 v117, 0xffff0000, v90
  v_lshlrev_b32 v118, 16, v91
  v_and_b32 v119, 0xffff0000, v91
  v_lshlrev_b32 v120, 16, v92
  v_and_b32 v121, 0xffff0000, v92
  v_lshlrev_b32 v122, 16, v93
  v_and_b32 v123, 0xffff0000, v93
  v_lshlrev_b32 v124, 16, v94
  v_and_b32 v125, 0xffff0000, v94
  v_lshlrev_b32 v126, 16, v95
  v_and_b32 v127, 0xffff0000, v95
  v_max3_f32 v96, v112, v113, v114
  v_max3_f32 v97, v115, v116, v117
  v_max3_f32 v98, v118, v119, v120
  v_max3_f32 v99, v121, v122, v123
  v_max3_f32 v96, v96, v124, v125
  v_max3_f32 v97, v97, v126, v127
  v_max3_f32 v96, v96, v98, v99
  v_max_f32 v96, v96, v97
  s_nop 1
  v_max_f32_dpp v96, v96, v96 row_ror:8 row_mask:0xf bank_mask:0xf
  v_mov_b32 v97, v96
  s_nop 1
  v_permlane16_swap_b32 v96, v97
  s_nop 1
  v_max_f32 v96, v96, v97
  v_mov_b32 v97, v96
  s_nop 1
  v_permlane32_swap_b32 v96, v97
  s_nop 1
  v_max_f32 v96, v96, v97
  v_mul_f32 v108, s7, v96
  v_sub_f32 v108, 0, v108
  v_fma_f32 v112, v112, s7, v108
  v_fma_f32 v113, v113, s7, v108
  v_fma_f32 v114, v114, s7, v108
  v_fma_f32 v115, v115, s7, v108
  v_fma_f32 v116, v116, s7, v108
  v_fma_f32 v117, v117, s7, v108
  v_fma_f32 v118, v118, s7, v108
  v_fma_f32 v119, v119, s7, v108
  v_fma_f32 v120, v120, s7, v108
  v_fma_f32 v121, v121, s7, v108
  v_fma_f32 v122, v122, s7, v108
  v_fma_f32 v123, v123, s7, v108
  v_fma_f32 v124, v124, s7, v108
  v_fma_f32 v125, v125, s7, v108
  v_fma_f32 v126, v126, s7, v108
  v_fma_f32 v127, v127, s7, v108
  v_exp_f32 v112, v112
  v_exp_f32 v113, v113
  v_exp_f32 v114, v114
  v_exp_f32 v115, v115
  v_exp_f32 v116, v116
  v_exp_f32 v117, v117
  v_exp_f32 v118, v118
  v_exp_f32 v119, v119
  v_exp_f32 v120, v120
  v_exp_f32 v121, v121
  v_exp_f32 v122, v122
  v_exp_f32 v123, v123
  v_exp_f32 v124, v124
  v_exp_f32 v125, v125
  v_exp_f32 v126, v126
  v_exp_f32 v127, v127
  v_cvt_pk_bf16_f32 v88, v112, v113
  v_cvt_pk_bf16_f32 v89, v114, v115
  v_cvt_pk_bf16_f32 v90, v116, v117
  v_cvt_pk_bf16_f32 v91, v118, v119
  v_cvt_pk_bf16_f32 v92, v120, v121
  v_cvt_pk_bf16_f32 v93, v122, v123
  v_cvt_pk_bf16_f32 v94, v124, v125
  v_cvt_pk_bf16_f32 v95, v126, v127
  v_perm_b32 v96, v88, v88, v80
  v_perm_b32 v97, v88, v88, v82
  v_perm_b32 v98, v88, v88, v84
  v_perm_b32 v99, v88, v88, v86
  v_perm_b32 v100, v88, v88, v81
  v_perm_b32 v101, v88, v88, v83
  v_perm_b32 v102, v88, v88, v85
  v_perm_b32 v103, v88, v88, v87
  v_pk_add_f32 v[112:113], v[112:113], v[114:115]
  s_waitcnt vmcnt(15)
  v_mfma_f32_16x16x32_bf16 v[104:107], v[96:99], v[16:19], 0
  v_perm_b32 v96, v89, v89, v80
  v_perm_b32 v97, v89, v89, v82
  v_perm_b32 v98, v89, v89, v84
  v_perm_b32 v99, v89, v89, v86
  v_pk_add_f32 v[116:117], v[116:117], v[118:119]
  s_waitcnt vmcnt(14)
  v_mfma_f32_16x16x32_bf16 v[104:107], v[100:103], v[20:23], v[104:107]
  v_perm_b32 v100, v89, v89, v81
  v_perm_b32 v101, v89, v89, v83
  v_perm_b32 v102, v89, v89, v85
  v_perm_b32 v103, v89, v89, v87
  v_pk_add_f32 v[120:121], v[120:121], v[122:123]
  s_waitcnt vmcnt(13)
  v_mfma_f32_16x16x32_bf16 v[104:107], v[96:99], v[24:27], v[104:107]
  v_perm_b32 v96, v90, v90, v80
  v_perm_b32 v97, v90, v90, v82
  v_perm_b32 v98, v90, v90, v84
  v_perm_b32 v99, v90, v90, v86
  v_pk_add_f32 v[124:125], v[124:125], v[126:127]
  s_waitcnt vmcnt(12)
  v_mfma_f32_16x16x32_bf16 v[104:107], v[100:103], v[28:31], v[104:107]
  v_perm_b32 v100, v90, v90, v81
  v_perm_b32 v101, v90, v90, v83
  v_perm_b32 v102, v90, v90, v85
  v_perm_b32 v103, v90, v90, v87
  v_pk_add_f32 v[112:113], v[112:113], v[116:117]
  s_waitcnt vmcnt(11)
  v_mfma_f32_16x16x32_bf16 v[104:107], v[96:99], v[32:35], v[104:107]
  v_perm_b32 v96, v91, v91, v80
  v_perm_b32 v97, v91, v91, v82
  v_perm_b32 v98, v91, v91, v84
  v_perm_b32 v99, v91, v91, v86
  v_pk_add_f32 v[120:121], v[120:121], v[124:125]
  s_waitcnt vmcnt(10)
  v_mfma_f32_16x16x32_bf16 v[104:107], v[100:103], v[36:39], v[104:107]
  v_perm_b32 v100, v91, v91, v81
  v_perm_b32 v101, v91, v91, v83
  v_perm_b32 v102, v91, v91, v85
  v_perm_b32 v103, v91, v91, v87
  v_pk_add_f32 v[112:113], v[112:113], v[120:121]
  s_waitcnt vmcnt(9)
  v_mfma_f32_16x16x32_bf16 v[104:107], v[96:99], v[40:43], v[104:107]
  v_perm_b32 v96, v92, v92, v80
  v_perm_b32 v97, v92, v92, v82
  v_perm_b32 v98, v92, v92, v84
  v_perm_b32 v99, v92, v92, v86
  v_add_f32 v109, v112, v113
  s_waitcnt vmcnt(8)
  v_mfma_f32_16x16x32_bf16 v[104:107], v[100:103], v[44:47], v[104:107]
  v_perm_b32 v100, v92, v92, v81
  v_perm_b32 v101, v92, v92, v83
  v_perm_b32 v102, v92, v92, v85
  v_perm_b32 v103, v92, v92, v87
  v_add_f32_dpp v109, v109, v109 row_ror:8 row_mask:0xf bank_mask:0xf
  s_waitcnt vmcnt(7)
  v_mfma_f32_16x16x32_bf16 v[104:107], v[96:99], v[48:51], v[104:107]
  v_perm_b32 v96, v93, v93, v80
  v_perm_b32 v97, v93, v93, v82
  v_perm_b32 v98, v93, v93, v84
  v_perm_b32 v99, v93, v93, v86
  v_mov_b32 v110, v109
  s_waitcnt vmcnt(6)
  v_mfma_f32_16x16x32_bf16 v[104:107], v[100:103], v[52:55], v[104:107]
  v_perm_b32 v100, v93, v93, v81
  v_perm_b32 v101, v93, v93, v83
  v_perm_b32 v102, v93, v93, v85
  v_perm_b32 v103, v93, v93, v87
  v_permlane16_swap_b32 v109, v110
  s_waitcnt vmcnt(5)
  v_mfma_f32_16x16x32_bf16 v[104:107], v[96:99], v[56:59], v[104:107]
  v_perm_b32 v96, v94, v94, v80
  v_perm_b32 v97, v94, v94, v82
  v_perm_b32 v98, v94, v94, v84
  v_perm_b32 v99, v94, v94, v86
  v_add_f32 v109, v109, v110
  s_waitcnt vmcnt(4)
  v_mfma_f32_16x16x32_bf16 v[104:107], v[100:103], v[60:63], v[104:107]
  v_perm_b32 v100, v94, v94, v81
  v_perm_b32 v101, v94, v94, v83
  v_perm_b32 v102, v94, v94, v85
  v_perm_b32 v103, v94, v94, v87
  v_mov_b32 v110, v109
  s_waitcnt vmcnt(3)
  v_mfma_f32_16x16x32_bf16 v[104:107], v[96:99], v[64:67], v[104:107]
  v_perm_b32 v96, v95, v95, v80
  v_perm_b32 v97, v95, v95, v82
  v_perm_b32 v98, v95, v95, v84
  v_perm_b32 v99, v95, v95, v86
  v_permlane32_swap_b32 v109, v110
  s_waitcnt vmcnt(2)
  v_mfma_f32_16x16x32_bf16 v[104:107], v[100:103], v[68:71], v[104:107]
  v_perm_b32 v100, v95, v95, v81
  v_perm_b32 v101, v95, v95, v83
  v_perm_b32 v102, v95, v95, v85
  v_perm_b32 v103, v95, v95, v87
  v_add_f32 v109, v109, v110
  s_waitcnt vmcnt(1)
  v_mfma_f32_16x16x32_bf16 v[104:107], v[96:99], v[72:75], v[104:107]
  s_nop 0
  s_waitcnt vmcnt(0)
  v_mfma_f32_16x16x32_bf16 v[104:107], v[100:103], v[76:79], v[104:107]
  s_mov_b64 exec, 1
  ds_write_b64 v1, v[108:109] offset:256
  s_mov_b32 exec_lo, 0x00ff00ff
  s_mov_b32 exec_hi, 0xff00ff00
  s_nop 4
  ds_write_b128 v14, v[104:107] offset:4096
  s_mov_b64 exec, 1
  ds_add_rtn_u32 v13, v10, v11 offset:24
  s_mov_b64 exec, -1
  s_waitcnt lgkmcnt(0)
  v_readfirstlane_b32 s101, v13
  s_cmp_lg_u32 s101, 7
  s_cbranch_scc1 L_end
  ds_read_b128 v[32:35], v10 offset:256
  ds_read_b128 v[36:39], v10 offset:272
  ds_read_b128 v[40:43], v10 offset:288
  ds_read_b128 v[44:47], v10 offset:304
  ds_read2st64_b32 v[16:17], v12 offset0:16 offset1:17
  ds_read2st64_b32 v[18:19], v12 offset0:18 offset1:19
  ds_read2st64_b32 v[20:21], v12 offset0:20 offset1:21
  ds_read2st64_b32 v[22:23], v12 offset0:22 offset1:23
  ds_read2st64_b32 v[24:25], v12 offset0:24 offset1:25
  ds_read2st64_b32 v[26:27], v12 offset0:26 offset1:27
  ds_read2st64_b32 v[28:29], v12 offset0:28 offset1:29
  ds_read2st64_b32 v[30:31], v12 offset0:30 offset1:31
  v_lshlrev_b32 v15, 1, v2
  s_waitcnt lgkmcnt(8)
  v_min3_f32 v48, v32, v34, v36
  v_min3_f32 v49, v38, v40, v42
  v_min3_f32 v48, v48, v44, v46
  v_min_f32 v48, v48, v49
  v_sub_f32 v32, v48, v32
  v_sub_f32 v34, v48, v34
  v_sub_f32 v36, v48, v36
  v_sub_f32 v38, v48, v38
  v_sub_f32 v40, v48, v40
  v_sub_f32 v42, v48, v42
  v_sub_f32 v44, v48, v44
  v_sub_f32 v46, v48, v46
  v_exp_f32 v32, v32
  v_exp_f32 v34, v34
  v_exp_f32 v36, v36
  v_exp_f32 v38, v38
  v_exp_f32 v40, v40
  v_exp_f32 v42, v42
  v_exp_f32 v44, v44
  v_exp_f32 v46, v46
  v_mul_f32 v48, v32, v33
  v_mul_f32 v49, v34, v35
  v_fma_f32 v48, v36, v37, v48
  v_fma_f32 v49, v38, v39, v49
  v_fma_f32 v48, v40, v41, v48
  v_fma_f32 v49, v42, v43, v49
  v_fma_f32 v48, v44, v45, v48
  v_fma_f32 v49, v46, v47, v49
  v_add_f32 v48, v48, v49
  v_rcp_f32 v48, v48
  s_waitcnt lgkmcnt(0)
  v_add_f32 v16, v16, v17
  v_add_f32 v18, v18, v19
  v_add_f32 v20, v20, v21
  v_add_f32 v22, v22, v23
  v_add_f32 v24, v24, v25
  v_add_f32 v26, v26, v27
  v_add_f32 v28, v28, v29
  v_add_f32 v30, v30, v31
  v_mul_f32 v50, v16, v32
  v_mul_f32 v51, v18, v34
  v_fma_f32 v50, v20, v36, v50
  v_fma_f32 v51, v22, v38, v51
  v_fma_f32 v50, v24, v40, v50
  v_fma_f32 v51, v26, v42, v51
  v_fma_f32 v50, v28, v44, v50
  v_fma_f32 v51, v30, v46, v51
  v_add_f32 v50, v50, v51
  v_mul_f32 v50, v50, v48
  v_cvt_pk_bf16_f32 v50, v50, v50
  ds_write_b16 v15, v50 offset:320
  s_mov_b64 exec, 1
  ds_write_b32 v10, v11 offset:36
  s_mov_b64 exec, -1
  s_mov_b32 s14, 4
  v_and_b32 v14, 15, v2
  v_bfe_u32 v15, v2, 4, 1
  v_lshlrev_b32 v14, 5, v14
  v_lshl_add_u32 v14, v15, 4, v14
L_spin13:
  ds_read_b32 v13, v10 offset:44
  s_waitcnt lgkmcnt(0)
  v_readfirstlane_b32 s101, v13
  s_cmp_ge_u32 s101, 1
  s_cbranch_scc1 L_spin13_done
  s_sub_u32 s100, s100, 1
  s_cbranch_scc1 L_end
  s_branch L_spin13
L_spin13_done:
  ds_read_b32 v13, v10 offset:84
  s_waitcnt lgkmcnt(0)
  v_readfirstlane_b32 s47, v13
  s_mul_i32 s45, s97, 20480
  s_mul_i32 s48, s14, 4096
  s_add_u32 s45, s45, s48
  s_add_u32 s45, s45, 0x401000
  s_add_u32 s48, s45, 2048
  s_mov_b32 s46, 0
  s_mov_b32 s54, 0x2000000
  s_sub_u32 s56, s54, s47
  s_sub_u32 s57, s47, 0x20000
  s_lshr_b32 s55, s47, 20
  s_sub_i32 s55, s55, 906
  s_max_i32 s55, s55, 0
  s_min_i32 s55, s55, 255
  s_lshl_b32 s55, s55, 23
  s_mul_i32 s49, s97, 1280
  s_lshl_b32 s50, s14, 8
  s_add_u32 s49, s49, s50
  v_lshrrev_b32 v120, 3, v2
  v_and_b32 v121, 7, v2
  v_mul_u32_u24 v120, 256, v120
  v_and_b32 v123, 15, v2
  v_lshl_add_u32 v120, v121, 3, v120
  v_bfe_u32 v121, v2, 4, 1
  v_lshlrev_b32 v123, 4, v123
  v_lshl_add_u32 v123, v121, 3, v123
  v_lshrrev_b32 v122, 5, v2
  v_lshl_add_u32 v121, v122, 2, v123
  s_mov_b32 s16, s24
  s_and_b32 s17, s25, 0xffff
  s_mov_b32 s18, 2560
  s_mov_b32 s19, 0x20000
L_spin14:
  ds_read_b32 v13, v10 offset:44
  s_waitcnt lgkmcnt(0)
  v_readfirstlane_b32 s101, v13
  s_cmp_ge_u32 s101, 4
  s_cbranch_scc1 L_spin14_done
  s_sub_u32 s100, s100, 1
  s_cbranch_scc1 L_end
  s_branch L_spin14
L_spin14_done:
  s_mov_b32 exec_hi, 0
  ds_read_b128 v[16:19], v14 offset:1024
  ds_read_b128 v[20:23], v14 offset:1536
  ds_read_b128 v[24:27], v14 offset:2048
  ds_read_b128 v[28:31], v14 offset:2560
  s_waitcnt lgkmcnt(2)
  v_pk_add_f32 v[16:17], v[16:17], v[20:21]
  v_pk_add_f32 v[18:19], v[18:19], v[22:23]
  s_waitcnt lgkmcnt(0)
  v_pk_add_f32 v[24:25], v[24:25], v[28:29]
  v_pk_add_f32 v[26:27], v[26:27], v[30:31]
  v_pk_add_f32 v[104:105], v[16:17], v[24:25]
  v_pk_add_f32 v[106:107], v[18:19], v[26:27]
  s_mov_b64 exec, -1
  s_nop 1
  s_branch L_bat
  s_branch L_end
L_end:
L_end0:
  s_endpgm
.section .rodata,"a"
.p2align 6
.amdhsa_kernel concat_heads__sliding_block_cached__sliding_block_cached__decode_kernel
  .amdhsa_next_free_vgpr 128
  .amdhsa_next_free_sgpr 102
  .amdhsa_accum_offset 128
  .amdhsa_group_segment_fixed_size 0
  .amdhsa_kernarg_size 104
  .amdhsa_user_sgpr_count 2
  .amdhsa_user_sgpr_kernarg_segment_ptr 1
  .amdhsa_system_sgpr_workgroup_id_x 1
.end_amdhsa_kernel
```
